```python
import torch

def _softmax(x, axis=-1):
    return torch.softmax(x, dim=axis)
def _gelu(x):
    return torch.nn.functional.gelu(x, approximate="tanh")
def _silu(x):
    return torch.nn.functional.silu(x)
def _sigmoid(x):
    return torch.sigmoid(x)
def _layernorm(x, axis=-1, eps=1e-5):
    m = x.mean(dim=axis, keepdim=True)
    v = x.var(dim=axis, keepdim=True, unbiased=False)
    return (x - m) / torch.sqrt(v + eps)
def _scatter_add(tgt, idx, src, axis=0):
    return tgt.clone().index_add_(axis, idx, src)
def _segment_sum(src, seg, n):
    out = torch.zeros((n,) + src.shape[1:], dtype=src.dtype)
    return out.index_add_(0, seg, src)
def _pad(x, pw):
    flat = tuple(v for pair in reversed(pw) for v in pair)
    return torch.nn.functional.pad(x, flat)

kernel_name = 'standalone__ssm_conv_s4__prompt'

def setup_inputs():

    _w = (lambda a: (lambda t: t.to(torch.bfloat16) if t.is_floating_point() else t)(torch.as_tensor(a)))
    B, L, D, N = 1, 2048, 512, 128
    A_re = -(lambda _x: torch.exp(torch.as_tensor(_x)))((lambda *s: torch.randn(*s, dtype=torch.bfloat16) * 6.4)(D, N))
    A_im = torch.pi * (lambda *s: torch.randn(*s, dtype=torch.bfloat16) * 0.05)(D, N)
    B_re = (lambda *s: torch.randn(*s, dtype=torch.bfloat16) * 0.1)(D, N)
    B_im = (lambda *s: torch.randn(*s, dtype=torch.bfloat16) * 0.1)(D, N)
    C_re = (lambda *s: torch.randn(*s, dtype=torch.bfloat16) * 0.1)(D, N)
    C_im = (lambda *s: torch.randn(*s, dtype=torch.bfloat16) * 0.1)(D, N)
    log_dt = (lambda *s: torch.randn(*s, dtype=torch.bfloat16) * 0.05)(D) * 0.5 - 4.0
    Dskip = (lambda *s: torch.randn(*s, dtype=torch.bfloat16) * 0.05)(D)
    return {
        "u": _w((lambda *s: torch.randn(*s, dtype=torch.bfloat16) * 0.05)(B, L, D)),
        "A_re": _w(A_re),
        "A_im": _w(A_im),
        "B_re": _w(B_re),
        "B_im": _w(B_im),
        "C_re": _w(C_re),
        "C_im": _w(C_im),
        "log_dt": _w(log_dt),
        "Dskip": _w(Dskip),
    }

def reference(u, A_re, A_im, B_re, B_im, C_re, C_im, log_dt, Dskip):
    Bsz, L, D = u.shape
    dt = torch.exp(log_dt)[:, None]
    A = A_re + 1j * A_im
    Bc = B_re + 1j * B_im
    Cc = C_re + 1j * C_im
    logdA = dt * A
    dB = dt * Bc
    l = (lambda x, dt: x.to(dt))(torch.arange(L), A_re.dtype)
    P = torch.exp(logdA[:, :, None] * l[None, None, :])
    K = torch.einsum("dn,dnl,dn->dl", Cc, P, dB).real
    L2 = 2 * L
    Kp = _pad(K, ((0, 0), (0, L)))
    up = (lambda x, *d: x.permute(*d))(u, 0, 2, 1)
    up = _pad(up, ((0, 0), (0, 0), (0, L)))
    Kf = (lambda x, axes=(-2,-1): torch.fft.rfft2(x.float(), dim=axes))(Kp[:, None, :], axes=(-2, -1))
    Uf = (lambda x, axes=(-2,-1): torch.fft.rfft2(x.float(), dim=axes))(up[:, :, None, :], axes=(-2, -1))
    Yf = Uf * Kf[None, :, :, :]
    y = (lambda x, s, axes=(-2,-1): torch.fft.irfft2(x, s=s, dim=axes).to(torch.bfloat16))(Yf, (1, L2), axes=(-2, -1))[:, :, 0, :L]
    y = (lambda x, *d: x.permute(*d))(y, 0, 2, 1) + u * Dskip[None, None, :]
    return y
```

```asm
; @launch grid=(256,1,1) block=(512,1,1) lds=157696
.amdgcn_target "amdgcn-amd-amdhsa--gfx950"
.text
.globl standalone__ssm_conv_s4__prompt_kernel
.p2align 12
.fill 0x340, 4, 0xBF800000
.p2align 8
.type standalone__ssm_conv_s4__prompt_kernel,@function
standalone__ssm_conv_s4__prompt_kernel:
    s_cmp_ge_u32 s2, 256
    s_cbranch_scc1 L_end
    s_load_dwordx16 s[16:31], s[0:1], 0
    s_load_dwordx4 s[32:35], s[0:1], 64
    v_lshrrev_b32 v13, 6, v0
    v_and_b32 v1, 63, v0
    v_readfirstlane_b32 s3, v13
    s_and_b32 s4, s2, 7
    s_lshr_b32 s5, s2, 3
    s_and_b32 s6, s5, 1
    s_lshr_b32 s66, s5, 1
    s_lshl_b32 s66, s66, 2
    s_lshl_b32 s7, s4, 6
    s_add_u32 s7, s7, s66
    s_and_b32 s9, s3, 3
    s_lshr_b32 s10, s3, 2
    s_add_u32 s8, s7, s9
    s_lshl_b32 s71, s7, 1
    s_mul_i32 s70, s9, 30208
    s_lshl_b32 s66, s8, 8
    v_lshlrev_b32 v123, 2, v1
    v_add_u32 v123, s66, v123
    v_mov_b32 v9, 0
    v_mov_b32 v12, 0
    s_cmp_eq_u32 s10, 0
    s_cbranch_scc1 L_wait
    v_lshrrev_b32 v9, 2, v1
    v_lshlrev_b32 v9, 5, v9
    v_and_b32 v15, 3, v1
    v_lshl_add_u32 v9, v15, 1, v9
    s_lshl_b32 s66, s9, 3
    v_add_u32 v9, s66, v9
    v_lshlrev_b32 v9, 10, v9
    v_add_u32 v9, s71, v9
    v_lshlrev_b32 v2, 3, v1
    v_add_u32 v2, s70, v2
    s_mov_b32 s44, 0x3fb8aa3b
    s_mov_b32 s45, 0x3e22f983
    s_mul_i32 s66, s9, 1280
    s_add_u32 s66, s66, 121072
    v_lshlrev_b32 v8, 2, v1
    v_add_u32 v8, s66, v8
    s_mov_b32 s46, 0x05040100
    s_mov_b32 s47, 0x07060302
    v_and_b32 v13, 1, v1
    v_bfe_u32 v14, v1, 1, 3
    s_xor_b32 s66, s6, 1
    v_xor_b32 v15, 1, v13
    v_and_b32 v15, s66, v15
    v_add_u32 v15, v14, v15
    v_lshlrev_b32 v15, 3, v15
    v_mul_u32_u24 v6, 4224, v13
    v_sub_u32 v6, v6, v15
    v_lshrrev_b32 v15, 4, v1
    v_lshlrev_b32 v15, 4, v15
    v_add_u32 v6, v6, v15
    s_add_u32 s66, s70, 64
    v_add_u32 v6, s66, v6
    v_lshrrev_b32 v14, 4, v1
    v_mul_u32_u24 v14, 1280, v14
    v_and_b32 v13, 15, v1
    v_lshlrev_b32 v15, 4, v13
    v_add_u32 v7, v14, v15
    s_mul_i32 s66, s9, 5120
    s_add_u32 s66, s66, 120832
    v_add_u32 v7, s66, v7
    v_lshlrev_b32 v14, 4, v1
    s_lshl_b32 s66, s9, 11
    s_add_u32 s66, s66, 142336
    v_add_u32 v10, s66, v14
    v_and_b32 v13, 7, v1
    v_lshrrev_b32 v14, 5, v1
    v_lshl_add_u32 v13, v14, 3, v13
    v_bfe_u32 v14, v1, 3, 2
    v_lshlrev_b32 v11, 4, v13
    v_lshl_add_u32 v11, v14, 2, v11
    s_lshl_b32 s66, s9, 8
    s_add_u32 s66, s66, 141312
    v_add_u32 v11, s66, v11
    v_lshlrev_b32 v12, 5, v13
    v_lshrrev_b32 v15, 1, v14
    v_lshl_add_u32 v12, v15, 2, v12
    v_and_b32 v14, 1, v14
    s_cmp_eq_u32 s6, 0
    s_cselect_b32 s68, -3, 1
    s_cselect_b32 s69, 3, 1
    v_mul_i32_i24 v14, s68, v14
    v_add_u32 v14, s69, v14
    v_add_u32 v12, v12, v14
    s_lshl_b32 s66, s9, 3
    v_add_u32 v12, s66, v12
    v_lshlrev_b32 v12, 10, v12
    v_add_u32 v12, s71, v12
L_wait:
    s_lshl_b32 s66, s8, 1
    v_mov_b32 v13, s66
    s_cmp_eq_u32 s10, 0
    s_waitcnt lgkmcnt(0)
    global_load_ushort v122, v13, s[30:31]
    global_load_dword v106, v123, s[18:19]
    global_load_dword v107, v123, s[20:21]
    s_cbranch_scc1 L_skipB
    global_load_dword v108, v123, s[22:23]
    global_load_dword v109, v123, s[24:25]
    global_load_dword v110, v123, s[26:27]
    global_load_dword v111, v123, s[28:29]
    global_load_ushort v121, v13, s[32:33]
    s_barrier
    s_add_u32 s52, s16, 524288
    s_addc_u32 s53, s17, 0
    s_add_u32 s54, s16, 1048576
    s_addc_u32 s55, s17, 0
    s_add_u32 s56, s16, 1572864
    s_addc_u32 s57, s17, 0
    s_mov_b64 exec, 0
    s_cmp_eq_u32 s3, 4
    s_cbranch_scc1 L_pg1
    s_cmp_eq_u32 s3, 5
    s_cbranch_scc1 L_pg2
L_back:
    s_mov_b64 exec, -1
    s_branch L_roleB
L_skipB:
    s_barrier
    v_and_b32 v13, 15, v1
    s_lshl_b32 s66, s5, 6
    s_lshl_b32 s68, s9, 4
    s_add_u32 s66, s66, s68
    v_add_u32 v15, s66, v13
    v_lshlrev_b32 v15, 10, v15
    s_lshl_b32 s66, s4, 7
    v_add_u32 v15, s66, v15
    v_mov_b32 v22, v15
    global_load_dword v23, v22, s[16:17]
    v_lshlrev_b32 v2, 3, v1
    v_add_u32 v2, s70, v2
    s_mov_b32 s44, 0x3fb8aa3b
    s_mov_b32 s45, 0x3e22f983
    v_and_b32 v13, 1, v1
    v_bfe_u32 v14, v1, 1, 3
    s_xor_b32 s66, s6, 1
    v_xor_b32 v15, 1, v13
    v_and_b32 v15, s66, v15
    v_add_u32 v15, v14, v15
    v_lshlrev_b32 v15, 3, v15
    v_mul_u32_u24 v6, 4224, v13
    v_sub_u32 v6, v6, v15
    v_lshrrev_b32 v15, 4, v1
    v_lshlrev_b32 v15, 4, v15
    v_add_u32 v6, v6, v15
    s_add_u32 s66, s70, 64
    v_add_u32 v6, s66, v6
    v_lshrrev_b32 v14, 4, v1
    v_mul_u32_u24 v14, 1280, v14
    v_and_b32 v13, 15, v1
    v_lshlrev_b32 v15, 4, v13
    v_add_u32 v7, v14, v15
    s_mul_i32 s66, s9, 5120
    s_add_u32 s66, s66, 120832
    v_add_u32 v7, s66, v7
    v_and_b32 v13, 31, v1
    v_lshrrev_b32 v14, 5, v1
    v_lshlrev_b32 v14, 4, v14
    v_add_u32 v14, s70, v14
    v_min_u32 v15, 24, v13
    v_mul_u32_u24 v15, 528, v15
    v_add_u32 v3, v14, v15
    v_mul_u32_u24 v15, 528, v13
    v_add_u32 v4, v14, v15
    v_add_u32 v4, 13200, v4
    v_lshlrev_b32 v13, 4, v1
    s_add_u32 s66, s70, 1008
    v_sub_u32 v5, s66, v13
    v_add_u32 v24, s70, v13
    v_and_b32 v25, 1, v1
    v_sub_u32 v25, 0, v25
    v_min_u32 v26, 1, v1
    v_add_u32 v26, -1, v26
    v_lshlrev_b32 v14, 4, v1
    s_lshl_b32 s66, s9, 11
    s_add_u32 s66, s66, 141312
    v_add_u32 v10, s66, v14
    v_and_b32 v13, 7, v1
    v_lshrrev_b32 v14, 5, v1
    v_lshl_add_u32 v13, v14, 3, v13
    v_bfe_u32 v14, v1, 3, 2
    v_lshlrev_b32 v11, 4, v13
    v_lshl_add_u32 v11, v14, 2, v11
    s_lshl_b32 s66, s9, 8
    s_add_u32 s66, s66, 141312
    v_add_u32 v11, s66, v11
    v_lshlrev_b32 v12, 5, v13
    v_lshrrev_b32 v15, 1, v14
    v_lshl_add_u32 v12, v15, 2, v12
    v_and_b32 v14, 1, v14
    s_cmp_eq_u32 s6, 0
    s_cselect_b32 s68, -3, 1
    s_cselect_b32 s69, 3, 1
    v_mul_i32_i24 v14, s68, v14
    v_add_u32 v14, s69, v14
    v_add_u32 v12, v12, v14
    s_lshl_b32 s66, s9, 3
    v_add_u32 v12, s66, v12
    v_lshlrev_b32 v12, 10, v12
    v_add_u32 v12, s71, v12
    s_add_u32 s58, s34, 0
    s_addc_u32 s59, s35, 0
    s_add_u32 s60, s34, 1048576
    s_addc_u32 s61, s35, 0
    v_lshrrev_b32 v14, 4, v1
    v_mul_u32_u24 v14, 5120, v14
    v_and_b32 v13, 15, v1
    v_lshl_add_u32 v14, v13, 4, v14
    s_mul_i32 s66, s9, 1280
    s_add_u32 s66, s66, 120832
    v_add_u32 v14, s66, v14
    v_mov_b32 v32, 0
    v_mov_b32 v33, 0
    v_mov_b32 v34, 0
    v_mov_b32 v35, 0
    s_mov_b32 exec_lo, 0x7fff7fff
    s_mov_b32 exec_hi, 0x7fff7fff
    ds_write_b128 v14, v[32:35]
    s_mov_b64 exec, -1
    s_waitcnt vmcnt(3)
    v_lshlrev_b32 v122, 16, v122
    v_mov_b32 v13, s44
    v_mul_f32 v14, v122, v13
    v_fma_f32 v15, v122, v13, -v14
    v_mov_b32 v13, 0x32a57060
    v_fma_f32 v15, v122, v13, v15
    v_exp_f32 v14, v14
    v_mul_f32 v15, 0x3f317218, v15
    v_fma_f32 v14, v14, v15, v14
    v_cvt_pk_bf16_f32 v14, v14, v14
    v_lshlrev_b32 v30, 16, v14
    v_mul_f32 v30, 0x41000000, v30
    v_mov_b32 v31, v30
    v_pk_mul_f32 v[28:29], v[30:31], s[44:45]
    s_waitcnt vmcnt(1)
    v_lshlrev_b32 v48, 16, v106
    v_lshlrev_b32 v49, 16, v107
    v_and_b32 v78, 0xffff0000, v106
    v_and_b32 v79, 0xffff0000, v107
    v_pk_mul_f32 v[48:49], v[48:49], v[28:29]
    v_pk_mul_f32 v[78:79], v[78:79], v[28:29]
    v_exp_f32 v76, v48
    v_exp_f32 v106, v78
    v_fract_f32 v77, v49
    v_fract_f32 v107, v79
    v_cos_f32 v52, v77
    v_cos_f32 v82, v107
    v_sin_f32 v53, v77
    v_sin_f32 v83, v107
    s_nop 0
    v_pk_mul_f32 v[52:53], v[52:53], v[76:77] op_sel_hi:[1,0]
    v_pk_mul_f32 v[82:83], v[82:83], v[106:107] op_sel_hi:[1,0]
    v_mov_b32 v112, 0x00003f80
    v_mov_b32 v113, 0x00003f80
    ds_write_b64 v2, v[112:113] offset:13200
    v_cvt_pk_bf16_f32 v114, v52, v53
    v_cvt_pk_bf16_f32 v115, v82, v83
    ds_write_b64 v2, v[114:115] offset:13728
    v_pk_mul_f32 v[60:61], v[52:53], v[52:53] op_sel_hi:[1,0]
    v_pk_fma_f32 v[62:63], v[52:53], v[52:53], v[60:61] op_sel:[1,1,0] op_sel_hi:[0,1,1] neg_lo:[0,1,0]
    v_pk_mul_f32 v[90:91], v[82:83], v[82:83] op_sel_hi:[1,0]
    v_pk_fma_f32 v[92:93], v[82:83], v[82:83], v[90:91] op_sel:[1,1,0] op_sel_hi:[0,1,1] neg_lo:[0,1,0]
    v_cvt_pk_bf16_f32 v116, v62, v63
    v_cvt_pk_bf16_f32 v117, v92, v93
    ds_write_b64 v2, v[116:117] offset:14256
    v_pk_mul_f32 v[60:61], v[62:63], v[52:53] op_sel_hi:[1,0]
    v_pk_fma_f32 v[62:63], v[62:63], v[52:53], v[60:61] op_sel:[1,1,0] op_sel_hi:[0,1,1] neg_lo:[0,1,0]
    v_pk_mul_f32 v[90:91], v[92:93], v[82:83] op_sel_hi:[1,0]
    v_pk_fma_f32 v[92:93], v[92:93], v[82:83], v[90:91] op_sel:[1,1,0] op_sel_hi:[0,1,1] neg_lo:[0,1,0]
    v_cvt_pk_bf16_f32 v118, v62, v63
    v_cvt_pk_bf16_f32 v119, v92, v93
    ds_write_b64 v2, v[118:119] offset:14784
    v_pk_mul_f32 v[60:61], v[62:63], v[52:53] op_sel_hi:[1,0]
    v_pk_fma_f32 v[62:63], v[62:63], v[52:53], v[60:61] op_sel:[1,1,0] op_sel_hi:[0,1,1] neg_lo:[0,1,0]
    v_pk_mul_f32 v[90:91], v[92:93], v[82:83] op_sel_hi:[1,0]
    v_pk_fma_f32 v[92:93], v[92:93], v[82:83], v[90:91] op_sel:[1,1,0] op_sel_hi:[0,1,1] neg_lo:[0,1,0]
    v_cvt_pk_bf16_f32 v112, v62, v63
    v_cvt_pk_bf16_f32 v113, v92, v93
    ds_write_b64 v2, v[112:113] offset:15312
    v_pk_mul_f32 v[60:61], v[62:63], v[52:53] op_sel_hi:[1,0]
    v_pk_fma_f32 v[62:63], v[62:63], v[52:53], v[60:61] op_sel:[1,1,0] op_sel_hi:[0,1,1] neg_lo:[0,1,0]
    v_pk_mul_f32 v[90:91], v[92:93], v[82:83] op_sel_hi:[1,0]
    v_pk_fma_f32 v[92:93], v[92:93], v[82:83], v[90:91] op_sel:[1,1,0] op_sel_hi:[0,1,1] neg_lo:[0,1,0]
    v_cvt_pk_bf16_f32 v114, v62, v63
    v_cvt_pk_bf16_f32 v115, v92, v93
    ds_write_b64 v2, v[114:115] offset:15840
    v_pk_mul_f32 v[60:61], v[62:63], v[52:53] op_sel_hi:[1,0]
    v_pk_fma_f32 v[62:63], v[62:63], v[52:53], v[60:61] op_sel:[1,1,0] op_sel_hi:[0,1,1] neg_lo:[0,1,0]
    v_pk_mul_f32 v[90:91], v[92:93], v[82:83] op_sel_hi:[1,0]
    v_pk_fma_f32 v[92:93], v[92:93], v[82:83], v[90:91] op_sel:[1,1,0] op_sel_hi:[0,1,1] neg_lo:[0,1,0]
    v_cvt_pk_bf16_f32 v116, v62, v63
    v_cvt_pk_bf16_f32 v117, v92, v93
    ds_write_b64 v2, v[116:117] offset:16368
    v_pk_mul_f32 v[60:61], v[62:63], v[52:53] op_sel_hi:[1,0]
    v_pk_fma_f32 v[62:63], v[62:63], v[52:53], v[60:61] op_sel:[1,1,0] op_sel_hi:[0,1,1] neg_lo:[0,1,0]
    v_pk_mul_f32 v[90:91], v[92:93], v[82:83] op_sel_hi:[1,0]
    v_pk_fma_f32 v[92:93], v[92:93], v[82:83], v[90:91] op_sel:[1,1,0] op_sel_hi:[0,1,1] neg_lo:[0,1,0]
    v_cvt_pk_bf16_f32 v118, v62, v63
    v_cvt_pk_bf16_f32 v119, v92, v93
    ds_write_b64 v2, v[118:119] offset:16896
    v_pk_mul_f32 v[60:61], v[62:63], v[52:53] op_sel_hi:[1,0]
    v_pk_fma_f32 v[62:63], v[62:63], v[52:53], v[60:61] op_sel:[1,1,0] op_sel_hi:[0,1,1] neg_lo:[0,1,0]
    v_pk_mul_f32 v[90:91], v[92:93], v[82:83] op_sel_hi:[1,0]
    v_pk_fma_f32 v[92:93], v[92:93], v[82:83], v[90:91] op_sel:[1,1,0] op_sel_hi:[0,1,1] neg_lo:[0,1,0]
    v_cvt_pk_bf16_f32 v112, v62, v63
    v_cvt_pk_bf16_f32 v113, v92, v93
    ds_write_b64 v2, v[112:113] offset:17424
    v_pk_mul_f32 v[60:61], v[62:63], v[52:53] op_sel_hi:[1,0]
    v_pk_fma_f32 v[62:63], v[62:63], v[52:53], v[60:61] op_sel:[1,1,0] op_sel_hi:[0,1,1] neg_lo:[0,1,0]
    v_pk_mul_f32 v[90:91], v[92:93], v[82:83] op_sel_hi:[1,0]
    v_pk_fma_f32 v[92:93], v[92:93], v[82:83], v[90:91] op_sel:[1,1,0] op_sel_hi:[0,1,1] neg_lo:[0,1,0]
    v_cvt_pk_bf16_f32 v114, v62, v63
    v_cvt_pk_bf16_f32 v115, v92, v93
    ds_write_b64 v2, v[114:115] offset:17952
    v_pk_mul_f32 v[60:61], v[62:63], v[52:53] op_sel_hi:[1,0]
    v_pk_fma_f32 v[62:63], v[62:63], v[52:53], v[60:61] op_sel:[1,1,0] op_sel_hi:[0,1,1] neg_lo:[0,1,0]
    v_pk_mul_f32 v[90:91], v[92:93], v[82:83] op_sel_hi:[1,0]
    v_pk_fma_f32 v[92:93], v[92:93], v[82:83], v[90:91] op_sel:[1,1,0] op_sel_hi:[0,1,1] neg_lo:[0,1,0]
    v_cvt_pk_bf16_f32 v116, v62, v63
    v_cvt_pk_bf16_f32 v117, v92, v93
    ds_write_b64 v2, v[116:117] offset:18480
    v_pk_mul_f32 v[60:61], v[62:63], v[52:53] op_sel_hi:[1,0]
    v_pk_fma_f32 v[62:63], v[62:63], v[52:53], v[60:61] op_sel:[1,1,0] op_sel_hi:[0,1,1] neg_lo:[0,1,0]
    v_pk_mul_f32 v[90:91], v[92:93], v[82:83] op_sel_hi:[1,0]
    v_pk_fma_f32 v[92:93], v[92:93], v[82:83], v[90:91] op_sel:[1,1,0] op_sel_hi:[0,1,1] neg_lo:[0,1,0]
    v_cvt_pk_bf16_f32 v118, v62, v63
    v_cvt_pk_bf16_f32 v119, v92, v93
    ds_write_b64 v2, v[118:119] offset:19008
    v_pk_mul_f32 v[60:61], v[62:63], v[52:53] op_sel_hi:[1,0]
    v_pk_fma_f32 v[62:63], v[62:63], v[52:53], v[60:61] op_sel:[1,1,0] op_sel_hi:[0,1,1] neg_lo:[0,1,0]
    v_pk_mul_f32 v[90:91], v[92:93], v[82:83] op_sel_hi:[1,0]
    v_pk_fma_f32 v[92:93], v[92:93], v[82:83], v[90:91] op_sel:[1,1,0] op_sel_hi:[0,1,1] neg_lo:[0,1,0]
    v_cvt_pk_bf16_f32 v112, v62, v63
    v_cvt_pk_bf16_f32 v113, v92, v93
    ds_write_b64 v2, v[112:113] offset:19536
    v_pk_mul_f32 v[60:61], v[62:63], v[52:53] op_sel_hi:[1,0]
    v_pk_fma_f32 v[62:63], v[62:63], v[52:53], v[60:61] op_sel:[1,1,0] op_sel_hi:[0,1,1] neg_lo:[0,1,0]
    v_pk_mul_f32 v[90:91], v[92:93], v[82:83] op_sel_hi:[1,0]
    v_pk_fma_f32 v[92:93], v[92:93], v[82:83], v[90:91] op_sel:[1,1,0] op_sel_hi:[0,1,1] neg_lo:[0,1,0]
    v_cvt_pk_bf16_f32 v114, v62, v63
    v_cvt_pk_bf16_f32 v115, v92, v93
    ds_write_b64 v2, v[114:115] offset:20064
    v_pk_mul_f32 v[60:61], v[62:63], v[52:53] op_sel_hi:[1,0]
    v_pk_fma_f32 v[62:63], v[62:63], v[52:53], v[60:61] op_sel:[1,1,0] op_sel_hi:[0,1,1] neg_lo:[0,1,0]
    v_pk_mul_f32 v[90:91], v[92:93], v[82:83] op_sel_hi:[1,0]
    v_pk_fma_f32 v[92:93], v[92:93], v[82:83], v[90:91] op_sel:[1,1,0] op_sel_hi:[0,1,1] neg_lo:[0,1,0]
    v_cvt_pk_bf16_f32 v116, v62, v63
    v_cvt_pk_bf16_f32 v117, v92, v93
    ds_write_b64 v2, v[116:117] offset:20592
    v_pk_mul_f32 v[60:61], v[62:63], v[52:53] op_sel_hi:[1,0]
    v_pk_fma_f32 v[62:63], v[62:63], v[52:53], v[60:61] op_sel:[1,1,0] op_sel_hi:[0,1,1] neg_lo:[0,1,0]
    v_pk_mul_f32 v[90:91], v[92:93], v[82:83] op_sel_hi:[1,0]
    v_pk_fma_f32 v[92:93], v[92:93], v[82:83], v[90:91] op_sel:[1,1,0] op_sel_hi:[0,1,1] neg_lo:[0,1,0]
    v_cvt_pk_bf16_f32 v118, v62, v63
    v_cvt_pk_bf16_f32 v119, v92, v93
    ds_write_b64 v2, v[118:119] offset:21120
    v_pk_mul_f32 v[60:61], v[62:63], v[52:53] op_sel_hi:[1,0]
    v_pk_fma_f32 v[62:63], v[62:63], v[52:53], v[60:61] op_sel:[1,1,0] op_sel_hi:[0,1,1] neg_lo:[0,1,0]
    v_pk_mul_f32 v[90:91], v[92:93], v[82:83] op_sel_hi:[1,0]
    v_pk_fma_f32 v[92:93], v[92:93], v[82:83], v[90:91] op_sel:[1,1,0] op_sel_hi:[0,1,1] neg_lo:[0,1,0]
    v_cvt_pk_bf16_f32 v112, v62, v63
    v_cvt_pk_bf16_f32 v113, v92, v93
    ds_write_b64 v2, v[112:113] offset:21648
    v_pk_mul_f32 v[60:61], v[62:63], v[52:53] op_sel_hi:[1,0]
    v_pk_fma_f32 v[62:63], v[62:63], v[52:53], v[60:61] op_sel:[1,1,0] op_sel_hi:[0,1,1] neg_lo:[0,1,0]
    v_pk_mul_f32 v[90:91], v[92:93], v[82:83] op_sel_hi:[1,0]
    v_pk_fma_f32 v[92:93], v[92:93], v[82:83], v[90:91] op_sel:[1,1,0] op_sel_hi:[0,1,1] neg_lo:[0,1,0]
    v_cvt_pk_bf16_f32 v114, v62, v63
    v_cvt_pk_bf16_f32 v115, v92, v93
    ds_write_b64 v2, v[114:115] offset:22176
    v_pk_mul_f32 v[60:61], v[62:63], v[52:53] op_sel_hi:[1,0]
    v_pk_fma_f32 v[62:63], v[62:63], v[52:53], v[60:61] op_sel:[1,1,0] op_sel_hi:[0,1,1] neg_lo:[0,1,0]
    v_pk_mul_f32 v[90:91], v[92:93], v[82:83] op_sel_hi:[1,0]
    v_pk_fma_f32 v[92:93], v[92:93], v[82:83], v[90:91] op_sel:[1,1,0] op_sel_hi:[0,1,1] neg_lo:[0,1,0]
    v_cvt_pk_bf16_f32 v116, v62, v63
    v_cvt_pk_bf16_f32 v117, v92, v93
    ds_write_b64 v2, v[116:117] offset:22704
    v_pk_mul_f32 v[60:61], v[62:63], v[52:53] op_sel_hi:[1,0]
    v_pk_fma_f32 v[62:63], v[62:63], v[52:53], v[60:61] op_sel:[1,1,0] op_sel_hi:[0,1,1] neg_lo:[0,1,0]
    v_pk_mul_f32 v[90:91], v[92:93], v[82:83] op_sel_hi:[1,0]
    v_pk_fma_f32 v[92:93], v[92:93], v[82:83], v[90:91] op_sel:[1,1,0] op_sel_hi:[0,1,1] neg_lo:[0,1,0]
    v_cvt_pk_bf16_f32 v118, v62, v63
    v_cvt_pk_bf16_f32 v119, v92, v93
    ds_write_b64 v2, v[118:119] offset:23232
    v_pk_mul_f32 v[60:61], v[62:63], v[52:53] op_sel_hi:[1,0]
    v_pk_fma_f32 v[62:63], v[62:63], v[52:53], v[60:61] op_sel:[1,1,0] op_sel_hi:[0,1,1] neg_lo:[0,1,0]
    v_pk_mul_f32 v[90:91], v[92:93], v[82:83] op_sel_hi:[1,0]
    v_pk_fma_f32 v[92:93], v[92:93], v[82:83], v[90:91] op_sel:[1,1,0] op_sel_hi:[0,1,1] neg_lo:[0,1,0]
    v_cvt_pk_bf16_f32 v112, v62, v63
    v_cvt_pk_bf16_f32 v113, v92, v93
    ds_write_b64 v2, v[112:113] offset:23760
    v_pk_mul_f32 v[60:61], v[62:63], v[52:53] op_sel_hi:[1,0]
    v_pk_fma_f32 v[62:63], v[62:63], v[52:53], v[60:61] op_sel:[1,1,0] op_sel_hi:[0,1,1] neg_lo:[0,1,0]
    v_pk_mul_f32 v[90:91], v[92:93], v[82:83] op_sel_hi:[1,0]
    v_pk_fma_f32 v[92:93], v[92:93], v[82:83], v[90:91] op_sel:[1,1,0] op_sel_hi:[0,1,1] neg_lo:[0,1,0]
    v_cvt_pk_bf16_f32 v114, v62, v63
    v_cvt_pk_bf16_f32 v115, v92, v93
    ds_write_b64 v2, v[114:115] offset:24288
    v_pk_mul_f32 v[60:61], v[62:63], v[52:53] op_sel_hi:[1,0]
    v_pk_fma_f32 v[62:63], v[62:63], v[52:53], v[60:61] op_sel:[1,1,0] op_sel_hi:[0,1,1] neg_lo:[0,1,0]
    v_pk_mul_f32 v[90:91], v[92:93], v[82:83] op_sel_hi:[1,0]
    v_pk_fma_f32 v[92:93], v[92:93], v[82:83], v[90:91] op_sel:[1,1,0] op_sel_hi:[0,1,1] neg_lo:[0,1,0]
    v_cvt_pk_bf16_f32 v116, v62, v63
    v_cvt_pk_bf16_f32 v117, v92, v93
    ds_write_b64 v2, v[116:117] offset:24816
    v_pk_mul_f32 v[60:61], v[62:63], v[52:53] op_sel_hi:[1,0]
    v_pk_fma_f32 v[62:63], v[62:63], v[52:53], v[60:61] op_sel:[1,1,0] op_sel_hi:[0,1,1] neg_lo:[0,1,0]
    v_pk_mul_f32 v[90:91], v[92:93], v[82:83] op_sel_hi:[1,0]
    v_pk_fma_f32 v[92:93], v[92:93], v[82:83], v[90:91] op_sel:[1,1,0] op_sel_hi:[0,1,1] neg_lo:[0,1,0]
    v_cvt_pk_bf16_f32 v118, v62, v63
    v_cvt_pk_bf16_f32 v119, v92, v93
    ds_write_b64 v2, v[118:119] offset:25344
    v_pk_mul_f32 v[60:61], v[62:63], v[52:53] op_sel_hi:[1,0]
    v_pk_fma_f32 v[62:63], v[62:63], v[52:53], v[60:61] op_sel:[1,1,0] op_sel_hi:[0,1,1] neg_lo:[0,1,0]
    v_pk_mul_f32 v[90:91], v[92:93], v[82:83] op_sel_hi:[1,0]
    v_pk_fma_f32 v[92:93], v[92:93], v[82:83], v[90:91] op_sel:[1,1,0] op_sel_hi:[0,1,1] neg_lo:[0,1,0]
    v_cvt_pk_bf16_f32 v112, v62, v63
    v_cvt_pk_bf16_f32 v113, v92, v93
    ds_write_b64 v2, v[112:113] offset:25872
    v_pk_mul_f32 v[60:61], v[62:63], v[52:53] op_sel_hi:[1,0]
    v_pk_fma_f32 v[62:63], v[62:63], v[52:53], v[60:61] op_sel:[1,1,0] op_sel_hi:[0,1,1] neg_lo:[0,1,0]
    v_pk_mul_f32 v[90:91], v[92:93], v[82:83] op_sel_hi:[1,0]
    v_pk_fma_f32 v[92:93], v[92:93], v[82:83], v[90:91] op_sel:[1,1,0] op_sel_hi:[0,1,1] neg_lo:[0,1,0]
    v_cvt_pk_bf16_f32 v114, v62, v63
    v_cvt_pk_bf16_f32 v115, v92, v93
    ds_write_b64 v2, v[114:115] offset:26400
    v_pk_mul_f32 v[60:61], v[62:63], v[52:53] op_sel_hi:[1,0]
    v_pk_fma_f32 v[62:63], v[62:63], v[52:53], v[60:61] op_sel:[1,1,0] op_sel_hi:[0,1,1] neg_lo:[0,1,0]
    v_pk_mul_f32 v[90:91], v[92:93], v[82:83] op_sel_hi:[1,0]
    v_pk_fma_f32 v[92:93], v[92:93], v[82:83], v[90:91] op_sel:[1,1,0] op_sel_hi:[0,1,1] neg_lo:[0,1,0]
    v_cvt_pk_bf16_f32 v116, v62, v63
    v_cvt_pk_bf16_f32 v117, v92, v93
    ds_write_b64 v2, v[116:117] offset:26928
    v_pk_mul_f32 v[60:61], v[62:63], v[52:53] op_sel_hi:[1,0]
    v_pk_fma_f32 v[62:63], v[62:63], v[52:53], v[60:61] op_sel:[1,1,0] op_sel_hi:[0,1,1] neg_lo:[0,1,0]
    v_pk_mul_f32 v[90:91], v[92:93], v[82:83] op_sel_hi:[1,0]
    v_pk_fma_f32 v[92:93], v[92:93], v[82:83], v[90:91] op_sel:[1,1,0] op_sel_hi:[0,1,1] neg_lo:[0,1,0]
    v_cvt_pk_bf16_f32 v118, v62, v63
    v_cvt_pk_bf16_f32 v119, v92, v93
    ds_write_b64 v2, v[118:119] offset:27456
    v_pk_mul_f32 v[60:61], v[62:63], v[52:53] op_sel_hi:[1,0]
    v_pk_fma_f32 v[62:63], v[62:63], v[52:53], v[60:61] op_sel:[1,1,0] op_sel_hi:[0,1,1] neg_lo:[0,1,0]
    v_pk_mul_f32 v[90:91], v[92:93], v[82:83] op_sel_hi:[1,0]
    v_pk_fma_f32 v[92:93], v[92:93], v[82:83], v[90:91] op_sel:[1,1,0] op_sel_hi:[0,1,1] neg_lo:[0,1,0]
    v_cvt_pk_bf16_f32 v112, v62, v63
    v_cvt_pk_bf16_f32 v113, v92, v93
    ds_write_b64 v2, v[112:113] offset:27984
    v_pk_mul_f32 v[60:61], v[62:63], v[52:53] op_sel_hi:[1,0]
    v_pk_fma_f32 v[62:63], v[62:63], v[52:53], v[60:61] op_sel:[1,1,0] op_sel_hi:[0,1,1] neg_lo:[0,1,0]
    v_pk_mul_f32 v[90:91], v[92:93], v[82:83] op_sel_hi:[1,0]
    v_pk_fma_f32 v[92:93], v[92:93], v[82:83], v[90:91] op_sel:[1,1,0] op_sel_hi:[0,1,1] neg_lo:[0,1,0]
    v_cvt_pk_bf16_f32 v114, v62, v63
    v_cvt_pk_bf16_f32 v115, v92, v93
    ds_write_b64 v2, v[114:115] offset:28512
    v_pk_mul_f32 v[60:61], v[62:63], v[52:53] op_sel_hi:[1,0]
    v_pk_fma_f32 v[62:63], v[62:63], v[52:53], v[60:61] op_sel:[1,1,0] op_sel_hi:[0,1,1] neg_lo:[0,1,0]
    v_pk_mul_f32 v[90:91], v[92:93], v[82:83] op_sel_hi:[1,0]
    v_pk_fma_f32 v[92:93], v[92:93], v[82:83], v[90:91] op_sel:[1,1,0] op_sel_hi:[0,1,1] neg_lo:[0,1,0]
    v_cvt_pk_bf16_f32 v116, v62, v63
    v_cvt_pk_bf16_f32 v117, v92, v93
    ds_write_b64 v2, v[116:117] offset:29040
    v_pk_mul_f32 v[60:61], v[62:63], v[52:53] op_sel_hi:[1,0]
    v_pk_fma_f32 v[62:63], v[62:63], v[52:53], v[60:61] op_sel:[1,1,0] op_sel_hi:[0,1,1] neg_lo:[0,1,0]
    v_pk_mul_f32 v[90:91], v[92:93], v[82:83] op_sel_hi:[1,0]
    v_pk_fma_f32 v[92:93], v[92:93], v[82:83], v[90:91] op_sel:[1,1,0] op_sel_hi:[0,1,1] neg_lo:[0,1,0]
    v_cvt_pk_bf16_f32 v118, v62, v63
    v_cvt_pk_bf16_f32 v119, v92, v93
    ds_write_b64 v2, v[118:119] offset:29568
    ds_read_b128 a[0:3], v4 offset:0
    ds_read_b128 a[4:7], v4 offset:32
    ds_read_b128 a[8:11], v4 offset:64
    ds_read_b128 a[12:15], v4 offset:96
    ds_read_b128 a[16:19], v4 offset:128
    ds_read_b128 a[20:23], v4 offset:160
    ds_read_b128 a[24:27], v4 offset:192
    ds_read_b128 a[28:31], v4 offset:224
    ds_read_b128 a[32:35], v4 offset:256
    s_waitcnt lgkmcnt(4)
    ds_read_b128 a[36:39], v4 offset:288
    ds_read_b128 a[40:43], v4 offset:320
    ds_read_b128 a[44:47], v4 offset:352
    ds_read_b128 a[48:51], v4 offset:384
    ds_read_b128 a[52:55], v4 offset:416
    ds_read_b128 a[56:59], v4 offset:448
    ds_read_b128 a[60:63], v4 offset:480
    s_waitcnt vmcnt(0) lgkmcnt(0)
    s_barrier
    ds_read_b128 v[48:51], v3 offset:0
    ds_read_b128 v[52:55], v3 offset:32
    ds_read_b128 v[56:59], v3 offset:64
    ds_read_b128 v[60:63], v3 offset:96
    ds_read_b128 v[64:67], v3 offset:128
    ds_read_b128 v[68:71], v3 offset:160
    ds_read_b128 v[72:75], v3 offset:192
    s_waitcnt lgkmcnt(6)
    v_mfma_f32_32x32x16_bf16 v[112:127], v[48:51], a[0:3], 0
    ds_read_b128 v[76:79], v3 offset:224
    s_waitcnt lgkmcnt(6)
    v_mfma_f32_32x32x16_bf16 v[112:127], v[52:55], a[4:7], v[112:127]
    ds_read_b128 v[48:51], v3 offset:256
    s_waitcnt lgkmcnt(6)
    v_mfma_f32_32x32x16_bf16 v[112:127], v[56:59], a[8:11], v[112:127]
    ds_read_b128 v[52:55], v3 offset:288
    s_waitcnt lgkmcnt(6)
    v_mfma_f32_32x32x16_bf16 v[112:127], v[60:63], a[12:15], v[112:127]
    ds_read_b128 v[56:59], v3 offset:320
    s_waitcnt lgkmcnt(6)
    v_mfma_f32_32x32x16_bf16 v[112:127], v[64:67], a[16:19], v[112:127]
    ds_read_b128 v[60:63], v3 offset:352
    s_waitcnt lgkmcnt(6)
    v_mfma_f32_32x32x16_bf16 v[112:127], v[68:71], a[20:23], v[112:127]
    ds_read_b128 v[64:67], v3 offset:384
    s_waitcnt lgkmcnt(6)
    v_mfma_f32_32x32x16_bf16 v[112:127], v[72:75], a[24:27], v[112:127]
    ds_read_b128 v[68:71], v3 offset:416
    s_waitcnt lgkmcnt(6)
    v_mfma_f32_32x32x16_bf16 v[112:127], v[76:79], a[28:31], v[112:127]
    ds_read_b128 v[72:75], v3 offset:448
    s_waitcnt lgkmcnt(6)
    v_mfma_f32_32x32x16_bf16 v[112:127], v[48:51], a[32:35], v[112:127]
    ds_read_b128 v[76:79], v3 offset:480
    s_waitcnt lgkmcnt(6)
    v_mfma_f32_32x32x16_bf16 v[112:127], v[52:55], a[36:39], v[112:127]
    s_waitcnt lgkmcnt(5)
    v_mfma_f32_32x32x16_bf16 v[112:127], v[56:59], a[40:43], v[112:127]
    s_waitcnt lgkmcnt(4)
    v_mfma_f32_32x32x16_bf16 v[112:127], v[60:63], a[44:47], v[112:127]
    s_waitcnt lgkmcnt(3)
    v_mfma_f32_32x32x16_bf16 v[112:127], v[64:67], a[48:51], v[112:127]
    s_waitcnt lgkmcnt(2)
    v_mfma_f32_32x32x16_bf16 v[112:127], v[68:71], a[52:55], v[112:127]
    s_waitcnt lgkmcnt(1)
    v_mfma_f32_32x32x16_bf16 v[112:127], v[72:75], a[56:59], v[112:127]
    s_waitcnt lgkmcnt(0)
    v_mfma_f32_32x32x16_bf16 v[112:127], v[76:79], a[60:63], v[112:127]
    s_nop 7
    s_nop 3
    s_cmp_eq_u32 s6, 0
    s_cbranch_scc0 L_epi1
    v_mov_b32_dpp v80, v120 wave_rol:1 row_mask:0xf bank_mask:0xf
    v_mov_b32_dpp v80, v112 wave_shl:1 row_mask:0xf bank_mask:0xf
    v_cvt_pk_bf16_f32 v88, v119, v118
    v_cvt_pk_bf16_f32 v89, v117, v116
    v_cvt_pk_bf16_f32 v90, v115, v114
    v_cvt_pk_bf16_f32 v91, v113, v112
    ds_write_b128 v5, v[88:91] offset:3072
    v_cvt_pk_bf16_f32 v92, v80, v119
    v_cvt_pk_bf16_f32 v93, v118, v117
    v_cvt_pk_bf16_f32 v94, v116, v115
    v_cvt_pk_bf16_f32 v95, v114, v113
    ds_write_b128 v5, v[92:95] offset:7296
    s_mov_b64 exec, 15
    v_mov_b32 v98, 0
    v_mov_b32 v99, 0
    v_mov_b32 v102, 0
    v_mov_b32 v103, 0
    v_mov_b32 v96, 0
    v_mov_b32 v97, 0
    ds_write_b128 v24, v[96:99] offset:4096
    v_cvt_pk_bf16_f32 v100, v112, 0
    v_cvt_pk_bf16_f32 v101, 0, 0
    v_and_b32 v100, v26, v100
    v_and_b32 v101, v26, v101
    ds_write_b128 v24, v[100:103] offset:8320
    s_mov_b64 exec, -1
    s_waitcnt lgkmcnt(0)
    s_barrier
    v_mov_b32_dpp v83, v122 wave_rol:1 row_mask:0xf bank_mask:0xf
    v_mov_b32_dpp v83, v120 wave_shl:1 row_mask:0xf bank_mask:0xf
    v_mov_b32_dpp v84, v123 wave_rol:1 row_mask:0xf bank_mask:0xf
    v_mov_b32_dpp v84, v122 wave_shl:1 row_mask:0xf bank_mask:0xf
    v_mov_b32_dpp v85, v124 wave_rol:1 row_mask:0xf bank_mask:0xf
    v_mov_b32_dpp v85, v123 wave_shl:1 row_mask:0xf bank_mask:0xf
    v_bfi_b32 v86, v25, v84, v122
    v_bfi_b32 v87, v25, v85, v123
    v_cvt_pk_bf16_f32 v88, v83, v83
    v_cvt_pk_bf16_f32 v89, v121, v121
    v_cvt_pk_bf16_f32 v90, v121, v120
    v_cvt_pk_bf16_f32 v91, v120, v120
    ds_write_b128 v5, v[88:91] offset:2048
    ds_read_b128 a[92:95], v7 offset:224
    ds_read_b128 a[124:127], v7 offset:480
    v_cvt_pk_bf16_f32 v92, v83, v83
    v_cvt_pk_bf16_f32 v93, v83, v121
    v_cvt_pk_bf16_f32 v94, v121, v121
    v_cvt_pk_bf16_f32 v95, v120, v120
    ds_write_b128 v5, v[92:95] offset:6272
    ds_read_b128 a[88:91], v7 offset:192
    ds_read_b128 a[120:123], v7 offset:448
    v_cvt_pk_bf16_f32 v88, v84, v84
    v_cvt_pk_bf16_f32 v89, v84, v86
    v_cvt_pk_bf16_f32 v90, v122, v122
    v_cvt_pk_bf16_f32 v91, v122, v122
    ds_write_b128 v5, v[88:91] offset:1024
    ds_read_b128 a[84:87], v7 offset:160
    ds_read_b128 a[116:119], v7 offset:416
    v_cvt_pk_bf16_f32 v92, v84, v84
    v_cvt_pk_bf16_f32 v93, v84, v84
    v_cvt_pk_bf16_f32 v94, v86, v122
    v_cvt_pk_bf16_f32 v95, v122, v122
    ds_write_b128 v5, v[92:95] offset:5248
    ds_read_b128 a[80:83], v7 offset:128
    ds_read_b128 a[112:115], v7 offset:384
    s_waitcnt lgkmcnt(6)
    v_cvt_pk_bf16_f32 v88, v85, v85
    v_cvt_pk_bf16_f32 v89, v85, v87
    v_cvt_pk_bf16_f32 v90, v123, v123
    v_cvt_pk_bf16_f32 v91, v123, v123
    ds_write_b128 v5, v[88:91] offset:0
    ds_read_b128 a[76:79], v7 offset:96
    ds_read_b128 a[108:111], v7 offset:352
    v_cvt_pk_bf16_f32 v92, v85, v85
    v_cvt_pk_bf16_f32 v93, v85, v85
    v_cvt_pk_bf16_f32 v94, v87, v123
    v_cvt_pk_bf16_f32 v95, v123, v123
    ds_write_b128 v5, v[92:95] offset:4224
    ds_read_b128 a[72:75], v7 offset:64
    ds_read_b128 a[104:107], v7 offset:320
    s_waitcnt lgkmcnt(8)
    ds_read_b128 a[68:71], v7 offset:32
L_pg1:
    s_cbranch_execz L_back
    ds_read_b128 a[100:103], v7 offset:288
    ds_read_b128 a[64:67], v7 offset:0
    ds_read_b128 a[96:99], v7 offset:256
    s_branch L_epi_done
L_epi1:
    v_mov_b32_dpp v80, v120 wave_rol:1 row_mask:0xf bank_mask:0xf
    v_mov_b32_dpp v80, v112 wave_shl:1 row_mask:0xf bank_mask:0xf
    v_mov_b32_dpp v81, v120 wave_rol:1 row_mask:0xf bank_mask:0xf
    v_mov_b32_dpp v81, v113 wave_shl:1 row_mask:0xf bank_mask:0xf
    v_mov_b32_dpp v82, v120 wave_rol:1 row_mask:0xf bank_mask:0xf
    v_mov_b32_dpp v82, v114 wave_shl:1 row_mask:0xf bank_mask:0xf
    v_cvt_pk_bf16_f32 v88, v81, v80
    v_cvt_pk_bf16_f32 v89, v119, v118
    v_cvt_pk_bf16_f32 v90, v117, v116
    v_cvt_pk_bf16_f32 v91, v115, v114
    ds_write_b128 v5, v[88:91] offset:3072
    v_cvt_pk_bf16_f32 v92, v82, v81
    v_cvt_pk_bf16_f32 v93, v80, v119
    v_cvt_pk_bf16_f32 v94, v118, v117
    v_cvt_pk_bf16_f32 v95, v116, v115
    ds_write_b128 v5, v[92:95] offset:7296
    s_mov_b64 exec, 15
    v_mov_b32 v98, 0
    v_mov_b32 v99, 0
    v_mov_b32 v102, 0
    v_mov_b32 v103, 0
    v_cvt_pk_bf16_f32 v96, v113, v112
    v_cvt_pk_bf16_f32 v97, 0, 0
    v_and_b32 v96, v26, v96
    v_and_b32 v97, v26, v97
    ds_write_b128 v24, v[96:99] offset:4096
    v_cvt_pk_bf16_f32 v100, v114, v113
    v_cvt_pk_bf16_f32 v101, v112, 0
    v_and_b32 v100, v26, v100
    v_and_b32 v101, v26, v101
    ds_write_b128 v24, v[100:103] offset:8320
    s_mov_b64 exec, -1
    s_waitcnt lgkmcnt(0)
    s_barrier
    v_mov_b32_dpp v83, v122 wave_rol:1 row_mask:0xf bank_mask:0xf
    v_mov_b32_dpp v83, v120 wave_shl:1 row_mask:0xf bank_mask:0xf
    v_mov_b32_dpp v84, v123 wave_rol:1 row_mask:0xf bank_mask:0xf
    v_mov_b32_dpp v84, v122 wave_shl:1 row_mask:0xf bank_mask:0xf
    v_mov_b32_dpp v85, v124 wave_rol:1 row_mask:0xf bank_mask:0xf
    v_mov_b32_dpp v85, v123 wave_shl:1 row_mask:0xf bank_mask:0xf
    v_bfi_b32 v86, v25, v84, v122
    v_bfi_b32 v87, v25, v85, v123
    v_cvt_pk_bf16_f32 v88, v83, v83
    v_cvt_pk_bf16_f32 v89, v83, v83
    v_cvt_pk_bf16_f32 v90, v121, v121
    v_cvt_pk_bf16_f32 v91, v121, v120
    ds_write_b128 v5, v[88:91] offset:2048
    ds_read_b128 a[92:95], v7 offset:224
    ds_read_b128 a[124:127], v7 offset:480
    v_cvt_pk_bf16_f32 v92, v83, v83
    v_cvt_pk_bf16_f32 v93, v83, v83
    v_cvt_pk_bf16_f32 v94, v83, v121
    v_cvt_pk_bf16_f32 v95, v121, v121
    ds_write_b128 v5, v[92:95] offset:6272
    ds_read_b128 a[88:91], v7 offset:192
    ds_read_b128 a[120:123], v7 offset:448
    v_cvt_pk_bf16_f32 v88, v84, v84
    v_cvt_pk_bf16_f32 v89, v84, v84
    v_cvt_pk_bf16_f32 v90, v84, v86
    v_cvt_pk_bf16_f32 v91, v122, v122
    ds_write_b128 v5, v[88:91] offset:1024
    ds_read_b128 a[84:87], v7 offset:160
    ds_read_b128 a[116:119], v7 offset:416
    v_cvt_pk_bf16_f32 v92, v84, v84
    v_cvt_pk_bf16_f32 v93, v84, v84
    v_cvt_pk_bf16_f32 v94, v84, v84
    v_cvt_pk_bf16_f32 v95, v86, v122
    ds_write_b128 v5, v[92:95] offset:5248
    ds_read_b128 a[80:83], v7 offset:128
    ds_read_b128 a[112:115], v7 offset:384
    s_waitcnt lgkmcnt(6)
    v_cvt_pk_bf16_f32 v88, v85, v85
    v_cvt_pk_bf16_f32 v89, v85, v85
    v_cvt_pk_bf16_f32 v90, v85, v87
    v_cvt_pk_bf16_f32 v91, v123, v123
    ds_write_b128 v5, v[88:91] offset:0
    ds_read_b128 a[76:79], v7 offset:96
    ds_read_b128 a[108:111], v7 offset:352
    v_cvt_pk_bf16_f32 v92, v85, v85
    v_cvt_pk_bf16_f32 v93, v85, v85
    v_cvt_pk_bf16_f32 v94, v85, v85
    v_cvt_pk_bf16_f32 v95, v87, v123
    ds_write_b128 v5, v[92:95] offset:4224
    ds_read_b128 a[72:75], v7 offset:64
    ds_read_b128 a[104:107], v7 offset:320
    s_waitcnt lgkmcnt(8)
    ds_read_b128 a[68:71], v7 offset:32
    ds_read_b128 a[100:103], v7 offset:288
    ds_read_b128 a[64:67], v7 offset:0
    ds_read_b128 a[96:99], v7 offset:256
L_epi_done:
    s_waitcnt lgkmcnt(0)
    s_barrier
    ds_read_b64 a[0:1], v6 offset:3968
    ds_read_b64 a[2:3], v6 offset:3976
    ds_read_b64 a[4:5], v6 offset:3840
    ds_read_b64 a[6:7], v6 offset:3848
    ds_read_b64 a[8:9], v6 offset:3712
    ds_read_b64 a[10:11], v6 offset:3720
    ds_read_b64 a[12:13], v6 offset:3584
    ds_read_b64 a[14:15], v6 offset:3592
    ds_read_b64 a[16:17], v6 offset:3456
    ds_read_b64 a[18:19], v6 offset:3464
    s_waitcnt lgkmcnt(8)
    v_mfma_f32_16x16x32_bf16 v[32:35], a[0:3], a[92:95], 0
    ds_read_b64 a[20:21], v6 offset:3328
    v_mfma_f32_16x16x32_bf16 v[36:39], a[0:3], a[124:127], 0
    ds_read_b64 a[22:23], v6 offset:3336
    s_waitcnt lgkmcnt(8)
    v_mfma_f32_16x16x32_bf16 v[32:35], a[4:7], a[88:91], v[32:35]
    ds_read_b64 a[24:25], v6 offset:3200
    v_mfma_f32_16x16x32_bf16 v[36:39], a[4:7], a[120:123], v[36:39]
    ds_read_b64 a[26:27], v6 offset:3208
    s_waitcnt lgkmcnt(8)
    v_mfma_f32_16x16x32_bf16 v[32:35], a[8:11], a[84:87], v[32:35]
    ds_read_b64 a[28:29], v6 offset:3072
    v_mfma_f32_16x16x32_bf16 v[36:39], a[8:11], a[116:119], v[36:39]
    ds_read_b64 a[30:31], v6 offset:3080
    s_waitcnt lgkmcnt(8)
    v_mfma_f32_16x16x32_bf16 v[32:35], a[12:15], a[80:83], v[32:35]
    ds_read_b64 a[32:33], v6 offset:2944
    v_mfma_f32_16x16x32_bf16 v[36:39], a[12:15], a[112:115], v[36:39]
    ds_read_b64 a[34:35], v6 offset:2952
    s_waitcnt lgkmcnt(8)
    v_mfma_f32_16x16x32_bf16 v[32:35], a[16:19], a[76:79], v[32:35]
    ds_read_b64 a[36:37], v6 offset:2816
    v_mfma_f32_16x16x32_bf16 v[36:39], a[16:19], a[108:111], v[36:39]
    ds_read_b64 a[38:39], v6 offset:2824
    s_waitcnt lgkmcnt(8)
    v_mfma_f32_16x16x32_bf16 v[32:35], a[20:23], a[72:75], v[32:35]
    ds_read_b64 a[40:41], v6 offset:2688
    v_mfma_f32_16x16x32_bf16 v[36:39], a[20:23], a[104:107], v[36:39]
    ds_read_b64 a[42:43], v6 offset:2696
    s_waitcnt lgkmcnt(8)
    v_mfma_f32_16x16x32_bf16 v[32:35], a[24:27], a[68:71], v[32:35]
    ds_read_b64 a[44:45], v6 offset:2560
    v_mfma_f32_16x16x32_bf16 v[36:39], a[24:27], a[100:103], v[36:39]
    ds_read_b64 a[46:47], v6 offset:2568
    s_waitcnt lgkmcnt(8)
    v_mfma_f32_16x16x32_bf16 v[32:35], a[28:31], a[64:67], v[32:35]
    ds_read_b64 a[48:49], v6 offset:2432
    v_mfma_f32_16x16x32_bf16 v[36:39], a[28:31], a[96:99], v[36:39]
    ds_read_b64 a[50:51], v6 offset:2440
    s_waitcnt lgkmcnt(8)
    v_mfma_f32_16x16x32_bf16 v[36:39], a[32:35], a[92:95], v[36:39]
    ds_read_b64 a[52:53], v6 offset:2304
    v_mfma_f32_16x16x32_bf16 v[40:43], a[32:35], a[124:127], 0
    s_nop 0
    ds_write_b128 v10, v[32:35] offset:0
    s_waitcnt lgkmcnt(8)
    v_mfma_f32_16x16x32_bf16 v[36:39], a[36:39], a[88:91], v[36:39]
    ds_read_b64 a[54:55], v6 offset:2312
    v_mfma_f32_16x16x32_bf16 v[40:43], a[36:39], a[120:123], v[40:43]
    ds_read_b64 a[56:57], v6 offset:2176
    s_waitcnt lgkmcnt(8)
    v_mfma_f32_16x16x32_bf16 v[36:39], a[40:43], a[84:87], v[36:39]
    ds_read_b64 a[58:59], v6 offset:2184
    v_mfma_f32_16x16x32_bf16 v[40:43], a[40:43], a[116:119], v[40:43]
    s_waitcnt lgkmcnt(3)
    s_barrier
    ds_read2st64_b32 v[104:105], v11 offset0:0 offset1:4
    v_mfma_f32_16x16x32_bf16 v[36:39], a[44:47], a[80:83], v[36:39]
    ds_read2st64_b32 v[106:107], v11 offset0:8 offset1:12
    v_mfma_f32_16x16x32_bf16 v[40:43], a[44:47], a[112:115], v[40:43]
    ds_read2st64_b32 v[108:109], v11 offset0:16 offset1:20
    v_mfma_f32_16x16x32_bf16 v[36:39], a[48:51], a[76:79], v[36:39]
    ds_read2st64_b32 v[110:111], v11 offset0:24 offset1:28
    v_mfma_f32_16x16x32_bf16 v[40:43], a[48:51], a[108:111], v[40:43]
    ds_read_b64 a[60:61], v6 offset:2048
    ds_read_b64 a[62:63], v6 offset:2056
    s_waitcnt lgkmcnt(8)
    v_mfma_f32_16x16x32_bf16 v[36:39], a[52:55], a[72:75], v[36:39]
    ds_read_b64 v[88:89], v6 offset:1920
    v_mfma_f32_16x16x32_bf16 v[40:43], a[52:55], a[104:107], v[40:43]
    ds_read_b64 v[90:91], v6 offset:1928
    s_waitcnt lgkmcnt(4)
    v_add_f32 v104, v104, v105
    v_add_f32 v106, v106, v107
    v_mfma_f32_16x16x32_bf16 v[36:39], a[56:59], a[68:71], v[36:39]
    ds_read_b64 v[92:93], v6 offset:1792
    v_add_f32 v108, v108, v109
    v_add_f32 v110, v110, v111
    v_mfma_f32_16x16x32_bf16 v[40:43], a[56:59], a[100:103], v[40:43]
    ds_read_b64 v[94:95], v6 offset:1800
    v_cvt_pk_bf16_f32 v104, v104, v106
    v_cvt_pk_bf16_f32 v105, v108, v110
    s_waitcnt lgkmcnt(4)
    v_mfma_f32_16x16x32_bf16 v[36:39], a[60:63], a[64:67], v[36:39]
    ds_read_b64 v[96:97], v6 offset:1664
    global_store_dwordx2 v12, v[104:105], s[58:59]
    v_mfma_f32_16x16x32_bf16 v[40:43], a[60:63], a[96:99], v[40:43]
    ds_read_b64 v[98:99], v6 offset:1672
    s_waitcnt lgkmcnt(4)
    v_mfma_f32_16x16x32_bf16 v[40:43], v[88:91], a[92:95], v[40:43]
    ds_read_b64 v[100:101], v6 offset:1536
    v_mfma_f32_16x16x32_bf16 v[44:47], v[88:91], a[124:127], 0
    ds_write_b128 v10, v[36:39] offset:8192
    ds_read_b64 v[102:103], v6 offset:1544
    s_waitcnt lgkmcnt(5)
    v_mfma_f32_16x16x32_bf16 v[40:43], v[92:95], a[88:91], v[40:43]
    ds_read_b64 v[88:89], v6 offset:1408
    v_mfma_f32_16x16x32_bf16 v[44:47], v[92:95], a[120:123], v[44:47]
    ds_read_b64 v[90:91], v6 offset:1416
    s_waitcnt lgkmcnt(5)
    v_mfma_f32_16x16x32_bf16 v[40:43], v[96:99], a[84:87], v[40:43]
    ds_read_b64 v[92:93], v6 offset:1280
    v_mfma_f32_16x16x32_bf16 v[44:47], v[96:99], a[116:119], v[44:47]
    s_waitcnt lgkmcnt(4)
    s_barrier
    ds_read_b64 v[94:95], v6 offset:1288
    s_waitcnt lgkmcnt(4)
    v_mfma_f32_16x16x32_bf16 v[40:43], v[100:103], a[80:83], v[40:43]
    ds_read_b64 v[96:97], v6 offset:1152
    v_mfma_f32_16x16x32_bf16 v[44:47], v[100:103], a[112:115], v[44:47]
    ds_read_b64 v[98:99], v6 offset:1160
    s_waitcnt lgkmcnt(4)
    v_mfma_f32_16x16x32_bf16 v[40:43], v[88:91], a[76:79], v[40:43]
    ds_read_b64 v[100:101], v6 offset:1024
    v_mfma_f32_16x16x32_bf16 v[44:47], v[88:91], a[108:111], v[44:47]
    ds_read_b64 v[102:103], v6 offset:1032
    s_waitcnt lgkmcnt(4)
    v_mfma_f32_16x16x32_bf16 v[40:43], v[92:95], a[72:75], v[40:43]
    ds_read_b128 v[48:51], v7 offset:512
    v_mfma_f32_16x16x32_bf16 v[44:47], v[92:95], a[104:107], v[44:47]
    ds_read_b128 v[52:55], v7 offset:544
    s_waitcnt lgkmcnt(4)
    v_mfma_f32_16x16x32_bf16 v[40:43], v[96:99], a[68:71], v[40:43]
    ds_read_b128 v[56:59], v7 offset:576
    v_mfma_f32_16x16x32_bf16 v[44:47], v[96:99], a[100:103], v[44:47]
    ds_read_b128 v[60:63], v7 offset:608
    s_waitcnt lgkmcnt(4)
    v_mfma_f32_16x16x32_bf16 v[40:43], v[100:103], a[64:67], v[40:43]
    v_mfma_f32_16x16x32_bf16 v[44:47], v[100:103], a[96:99], v[44:47]
    s_waitcnt lgkmcnt(3)
    v_mfma_f32_16x16x32_bf16 v[40:43], a[28:31], v[48:51], v[40:43]
    v_mfma_f32_16x16x32_bf16 v[44:47], a[60:63], v[48:51], v[44:47]
    ds_read_b128 v[48:51], v7 offset:640
    s_waitcnt lgkmcnt(3)
    v_mfma_f32_16x16x32_bf16 v[40:43], a[24:27], v[52:55], v[40:43]
    v_mfma_f32_16x16x32_bf16 v[44:47], a[56:59], v[52:55], v[44:47]
    ds_read_b128 v[52:55], v7 offset:672
    s_waitcnt lgkmcnt(3)
    v_mfma_f32_16x16x32_bf16 v[40:43], a[20:23], v[56:59], v[40:43]
    v_mfma_f32_16x16x32_bf16 v[44:47], a[52:55], v[56:59], v[44:47]
    ds_read_b128 v[56:59], v7 offset:704
    s_waitcnt lgkmcnt(3)
    v_mfma_f32_16x16x32_bf16 v[40:43], a[16:19], v[60:63], v[40:43]
    v_mfma_f32_16x16x32_bf16 v[44:47], a[48:51], v[60:63], v[44:47]
    ds_read_b128 v[60:63], v7 offset:736
    s_waitcnt lgkmcnt(3)
    v_mfma_f32_16x16x32_bf16 v[40:43], a[12:15], v[48:51], v[40:43]
    ds_read_b64 v[88:89], v6 offset:896
    v_mfma_f32_16x16x32_bf16 v[44:47], a[44:47], v[48:51], v[44:47]
    ds_read_b64 v[90:91], v6 offset:904
    s_waitcnt lgkmcnt(4)
    v_mfma_f32_16x16x32_bf16 v[40:43], a[8:11], v[52:55], v[40:43]
    ds_read_b128 v[48:51], v7 offset:768
    v_mfma_f32_16x16x32_bf16 v[44:47], a[40:43], v[52:55], v[44:47]
    ds_read_b64 v[92:93], v6 offset:768
    s_waitcnt lgkmcnt(5)
    v_mfma_f32_16x16x32_bf16 v[40:43], a[4:7], v[56:59], v[40:43]
    ds_read_b64 v[94:95], v6 offset:776
    v_mfma_f32_16x16x32_bf16 v[44:47], a[36:39], v[56:59], v[44:47]
    ds_read_b128 v[52:55], v7 offset:800
    s_waitcnt lgkmcnt(6)
    v_mfma_f32_16x16x32_bf16 v[40:43], a[0:3], v[60:63], v[40:43]
    ds_read_b64 v[96:97], v6 offset:640
    v_mfma_f32_16x16x32_bf16 v[44:47], a[32:35], v[60:63], v[44:47]
    ds_read_b64 v[98:99], v6 offset:648
    s_waitcnt lgkmcnt(6)
    v_mfma_f32_16x16x32_bf16 v[44:47], v[88:91], a[92:95], v[44:47]
    ds_read_b128 v[56:59], v7 offset:832
    s_waitcnt lgkmcnt(6)
    v_mfma_f32_16x16x32_bf16 v[44:47], a[28:31], v[48:51], v[44:47]
    ds_write_b128 v10, v[40:43] offset:0
    ds_read_b64 v[100:101], v6 offset:512
    ds_read_b64 v[102:103], v6 offset:520
    s_waitcnt lgkmcnt(7)
    v_mfma_f32_16x16x32_bf16 v[44:47], v[92:95], a[88:91], v[44:47]
    ds_read_b128 v[60:63], v7 offset:864
    s_waitcnt lgkmcnt(7)
    v_mfma_f32_16x16x32_bf16 v[44:47], a[24:27], v[52:55], v[44:47]
    ds_read_b64 v[88:89], v6 offset:384
    ds_read_b64 v[90:91], v6 offset:392
    s_waitcnt lgkmcnt(7)
    v_mfma_f32_16x16x32_bf16 v[44:47], v[96:99], a[84:87], v[44:47]
    ds_read_b128 v[48:51], v7 offset:896
    s_waitcnt lgkmcnt(7)
    v_mfma_f32_16x16x32_bf16 v[44:47], a[20:23], v[56:59], v[44:47]
    s_waitcnt lgkmcnt(6)
    s_barrier
    ds_read2st64_b32 v[104:105], v11 offset0:0 offset1:4
    ds_read_b64 v[92:93], v6 offset:256
    ds_read_b64 v[94:95], v6 offset:264
    s_waitcnt lgkmcnt(7)
    v_mfma_f32_16x16x32_bf16 v[44:47], v[100:103], a[80:83], v[44:47]
    ds_read2st64_b32 v[106:107], v11 offset0:8 offset1:12
    ds_read_b128 v[52:55], v7 offset:928
    s_waitcnt lgkmcnt(8)
    v_mfma_f32_16x16x32_bf16 v[44:47], a[16:19], v[60:63], v[44:47]
    ds_read2st64_b32 v[108:109], v11 offset0:16 offset1:20
    ds_read_b64 v[96:97], v6 offset:128
    ds_read_b64 v[98:99], v6 offset:136
    s_waitcnt lgkmcnt(9)
    v_mfma_f32_16x16x32_bf16 v[44:47], v[88:91], a[76:79], v[44:47]
    ds_read2st64_b32 v[110:111], v11 offset0:24 offset1:28
    ds_read_b128 v[56:59], v7 offset:960
    s_waitcnt lgkmcnt(10)
    v_mfma_f32_16x16x32_bf16 v[44:47], a[12:15], v[48:51], v[44:47]
    ds_read_b64 v[100:101], v6 offset:0
    ds_read_b64 v[102:103], v6 offset:8
    s_waitcnt lgkmcnt(9)
    v_mfma_f32_16x16x32_bf16 v[44:47], v[92:95], a[72:75], v[44:47]
    ds_read_b128 v[60:63], v7 offset:992
    s_waitcnt lgkmcnt(8)
    v_mfma_f32_16x16x32_bf16 v[44:47], a[8:11], v[52:55], v[44:47]
    s_waitcnt lgkmcnt(4)
    v_add_f32 v104, v104, v105
    v_add_f32 v106, v106, v107
    v_mfma_f32_16x16x32_bf16 v[44:47], v[96:99], a[68:71], v[44:47]
    v_add_f32 v108, v108, v109
    v_add_f32 v110, v110, v111
    s_waitcnt lgkmcnt(3)
    v_mfma_f32_16x16x32_bf16 v[44:47], a[4:7], v[56:59], v[44:47]
    v_cvt_pk_bf16_f32 v104, v104, v106
    v_cvt_pk_bf16_f32 v105, v108, v110
    s_waitcnt lgkmcnt(1)
    v_mfma_f32_16x16x32_bf16 v[44:47], v[100:103], a[64:67], v[44:47]
    global_store_dwordx2 v12, v[104:105], s[60:61]
    s_waitcnt lgkmcnt(0)
    v_mfma_f32_16x16x32_bf16 v[44:47], a[0:3], v[60:63], v[44:47]
    s_nop 7
    ds_write_b128 v10, v[44:47] offset:8192
    s_waitcnt lgkmcnt(0)
    s_barrier
    s_endpgm
L_roleB:
    s_mov_b32 s42, 0x43800000
    s_mov_b32 s43, 0x43800000
    s_add_u32 s58, s34, 524288
    s_addc_u32 s59, s35, 0
    s_add_u32 s60, s34, 1572864
    s_addc_u32 s61, s35, 0
    v_and_b32 v13, 1, v1
    v_bfe_u32 v14, v1, 1, 3
    v_lshlrev_b32 v14, 2, v14
    s_cmp_eq_u32 s6, 0
    s_cselect_b32 s68, -3, 1
    s_cselect_b32 s69, 3, 1
    v_mul_i32_i24 v33, s68, v13
    v_add_u32 v33, s69, v33
    v_add_u32 v14, v14, v33
    v_lshrrev_b32 v15, 4, v1
    v_lshlrev_b32 v15, 3, v15
    v_sub_u32 v24, v14, v15
    s_waitcnt vmcnt(7)
    v_lshlrev_b32 v122, 16, v122
    v_mov_b32 v13, s44
    v_mul_f32 v14, v122, v13
    v_fma_f32 v15, v122, v13, -v14
    v_mov_b32 v13, 0x32a57060
    v_fma_f32 v15, v122, v13, v15
    v_exp_f32 v14, v14
    v_mul_f32 v15, 0x3f317218, v15
    v_fma_f32 v14, v14, v15, v14
    v_cvt_pk_bf16_f32 v14, v14, v14
    v_lshlrev_b32 v30, 16, v14
    v_mov_b32 v31, v30
    v_pk_mul_f32 v[28:29], v[30:31], s[44:45]
    s_waitcnt vmcnt(0)
    global_load_dwordx2 v[16:17], v9, s[16:17]
    global_load_dwordx2 v[18:19], v9, s[16:17] offset:1024
    global_load_dwordx2 v[20:21], v9, s[52:53]
    global_load_dwordx2 v[22:23], v9, s[52:53] offset:1024
    v_lshlrev_b32 v48, 16, v106
    v_lshlrev_b32 v49, 16, v107
    v_lshlrev_b32 v72, 16, v108
    v_lshlrev_b32 v73, 16, v109
    v_lshlrev_b32 v74, 16, v110
    v_lshlrev_b32 v75, 16, v111
    v_and_b32 v78, 0xffff0000, v106
    v_and_b32 v79, 0xffff0000, v107
    v_and_b32 v102, 0xffff0000, v108
    v_and_b32 v103, 0xffff0000, v109
    v_and_b32 v104, 0xffff0000, v110
    v_and_b32 v105, 0xffff0000, v111
    v_pk_mul_f32 v[48:49], v[48:49], v[28:29]
    v_pk_mul_f32 v[78:79], v[78:79], v[28:29]
    v_pk_mul_f32 v[60:61], v[74:75], v[72:73] op_sel_hi:[1,0]
    v_pk_fma_f32 v[50:51], v[74:75], v[72:73], v[60:61] op_sel:[1,1,0] op_sel_hi:[0,1,1] neg_lo:[0,1,0]
    v_pk_mul_f32 v[90:91], v[104:105], v[102:103] op_sel_hi:[1,0]
    v_pk_fma_f32 v[80:81], v[104:105], v[102:103], v[90:91] op_sel:[1,1,0] op_sel_hi:[0,1,1] neg_lo:[0,1,0]
    v_pk_mul_f32 v[50:51], v[50:51], v[30:31] neg_hi:[1,0]
    v_pk_mul_f32 v[80:81], v[80:81], v[30:31] neg_hi:[1,0]
    v_exp_f32 v76, v48
    v_exp_f32 v106, v78
    v_fract_f32 v77, v49
    v_fract_f32 v107, v79
    v_cos_f32 v52, v77
    v_cos_f32 v82, v107
    v_sin_f32 v53, v77
    v_sin_f32 v83, v107
    s_nop 0
    v_pk_mul_f32 v[52:53], v[52:53], v[76:77] op_sel_hi:[1,0]
    v_pk_mul_f32 v[82:83], v[82:83], v[106:107] op_sel_hi:[1,0]
    v_pk_mul_f32 v[60:61], v[48:49], s[42:43]
    v_pk_mul_f32 v[90:91], v[78:79], s[42:43]
    v_exp_f32 v76, v60
    v_exp_f32 v106, v90
    v_fract_f32 v77, v61
    v_fract_f32 v107, v91
    v_cos_f32 v58, v77
    v_cos_f32 v88, v107
    v_sin_f32 v59, v77
    v_sin_f32 v89, v107
    s_nop 0
    v_pk_mul_f32 v[58:59], v[58:59], v[76:77] op_sel_hi:[1,0]
    v_pk_mul_f32 v[88:89], v[88:89], v[106:107] op_sel_hi:[1,0]
    v_cvt_pk_bf16_f32 v112, v50, v51
    v_cvt_pk_bf16_f32 v113, v80, v81
    ds_write_b64 v2, v[112:113] offset:0
    v_pk_mul_f32 v[60:61], v[52:53], v[52:53] op_sel_hi:[1,0]
    v_pk_fma_f32 v[54:55], v[52:53], v[52:53], v[60:61] op_sel:[1,1,0] op_sel_hi:[0,1,1] neg_lo:[0,1,0]
    v_pk_mul_f32 v[90:91], v[82:83], v[82:83] op_sel_hi:[1,0]
    v_pk_fma_f32 v[84:85], v[82:83], v[82:83], v[90:91] op_sel:[1,1,0] op_sel_hi:[0,1,1] neg_lo:[0,1,0]
    v_pk_mul_f32 v[60:61], v[54:55], v[54:55] op_sel_hi:[1,0]
    v_pk_fma_f32 v[56:57], v[54:55], v[54:55], v[60:61] op_sel:[1,1,0] op_sel_hi:[0,1,1] neg_lo:[0,1,0]
    v_pk_mul_f32 v[90:91], v[84:85], v[84:85] op_sel_hi:[1,0]
    v_pk_fma_f32 v[86:87], v[84:85], v[84:85], v[90:91] op_sel:[1,1,0] op_sel_hi:[0,1,1] neg_lo:[0,1,0]
    v_pk_mul_f32 v[60:61], v[50:51], v[52:53] op_sel_hi:[1,0]
    v_pk_fma_f32 v[62:63], v[50:51], v[52:53], v[60:61] op_sel:[1,1,0] op_sel_hi:[0,1,1] neg_hi:[0,1,0]
    v_pk_mul_f32 v[90:91], v[80:81], v[82:83] op_sel_hi:[1,0]
    v_pk_fma_f32 v[92:93], v[80:81], v[82:83], v[90:91] op_sel:[1,1,0] op_sel_hi:[0,1,1] neg_hi:[0,1,0]
    v_cvt_pk_bf16_f32 v114, v62, v63
    v_cvt_pk_bf16_f32 v115, v92, v93
    ds_write_b64 v2, v[114:115] offset:528
    v_pk_mul_f32 v[60:61], v[62:63], v[52:53] op_sel_hi:[1,0]
    v_pk_fma_f32 v[66:67], v[62:63], v[52:53], v[60:61] op_sel:[1,1,0] op_sel_hi:[0,1,1] neg_hi:[0,1,0]
    v_pk_mul_f32 v[90:91], v[92:93], v[82:83] op_sel_hi:[1,0]
    v_pk_fma_f32 v[96:97], v[92:93], v[82:83], v[90:91] op_sel:[1,1,0] op_sel_hi:[0,1,1] neg_hi:[0,1,0]
    v_cvt_pk_bf16_f32 v116, v66, v67
    v_cvt_pk_bf16_f32 v117, v96, v97
    ds_write_b64 v2, v[116:117] offset:1056
    v_pk_mul_f32 v[60:61], v[66:67], v[52:53] op_sel_hi:[1,0]
    v_pk_fma_f32 v[62:63], v[66:67], v[52:53], v[60:61] op_sel:[1,1,0] op_sel_hi:[0,1,1] neg_hi:[0,1,0]
    v_pk_mul_f32 v[90:91], v[96:97], v[82:83] op_sel_hi:[1,0]
    v_pk_fma_f32 v[92:93], v[96:97], v[82:83], v[90:91] op_sel:[1,1,0] op_sel_hi:[0,1,1] neg_hi:[0,1,0]
    v_cvt_pk_bf16_f32 v118, v62, v63
    v_cvt_pk_bf16_f32 v119, v92, v93
    ds_write_b64 v2, v[118:119] offset:1584
    v_pk_mul_f32 v[60:61], v[62:63], v[52:53] op_sel_hi:[1,0]
    v_pk_fma_f32 v[68:69], v[62:63], v[52:53], v[60:61] op_sel:[1,1,0] op_sel_hi:[0,1,1] neg_hi:[0,1,0]
    v_pk_mul_f32 v[90:91], v[92:93], v[82:83] op_sel_hi:[1,0]
    v_pk_fma_f32 v[98:99], v[92:93], v[82:83], v[90:91] op_sel:[1,1,0] op_sel_hi:[0,1,1] neg_hi:[0,1,0]
    v_cvt_pk_bf16_f32 v112, v68, v69
    v_cvt_pk_bf16_f32 v113, v98, v99
    ds_write_b64 v2, v[112:113] offset:4224
    v_pk_mul_f32 v[60:61], v[68:69], v[52:53] op_sel_hi:[1,0]
    v_pk_fma_f32 v[62:63], v[68:69], v[52:53], v[60:61] op_sel:[1,1,0] op_sel_hi:[0,1,1] neg_hi:[0,1,0]
    v_pk_mul_f32 v[90:91], v[98:99], v[82:83] op_sel_hi:[1,0]
    v_pk_fma_f32 v[92:93], v[98:99], v[82:83], v[90:91] op_sel:[1,1,0] op_sel_hi:[0,1,1] neg_hi:[0,1,0]
    v_cvt_pk_bf16_f32 v114, v62, v63
    v_cvt_pk_bf16_f32 v115, v92, v93
    ds_write_b64 v2, v[114:115] offset:4752
    v_pk_mul_f32 v[60:61], v[62:63], v[52:53] op_sel_hi:[1,0]
    v_pk_fma_f32 v[70:71], v[62:63], v[52:53], v[60:61] op_sel:[1,1,0] op_sel_hi:[0,1,1] neg_hi:[0,1,0]
    v_pk_mul_f32 v[90:91], v[92:93], v[82:83] op_sel_hi:[1,0]
    v_pk_fma_f32 v[100:101], v[92:93], v[82:83], v[90:91] op_sel:[1,1,0] op_sel_hi:[0,1,1] neg_hi:[0,1,0]
    v_cvt_pk_bf16_f32 v116, v70, v71
    v_cvt_pk_bf16_f32 v117, v100, v101
    ds_write_b64 v2, v[116:117] offset:5280
    v_pk_mul_f32 v[60:61], v[70:71], v[52:53] op_sel_hi:[1,0]
    v_pk_fma_f32 v[62:63], v[70:71], v[52:53], v[60:61] op_sel:[1,1,0] op_sel_hi:[0,1,1] neg_hi:[0,1,0]
    v_pk_mul_f32 v[90:91], v[100:101], v[82:83] op_sel_hi:[1,0]
    v_pk_fma_f32 v[92:93], v[100:101], v[82:83], v[90:91] op_sel:[1,1,0] op_sel_hi:[0,1,1] neg_hi:[0,1,0]
    v_cvt_pk_bf16_f32 v118, v62, v63
    v_cvt_pk_bf16_f32 v119, v92, v93
    ds_write_b64 v2, v[118:119] offset:5808
    global_load_dwordx2 v[124:125], v9, s[54:55]
    global_load_dwordx2 v[126:127], v9, s[54:55] offset:1024
    v_pk_mul_f32 v[60:61], v[50:51], v[58:59] op_sel_hi:[1,0]
    v_pk_fma_f32 v[64:65], v[50:51], v[58:59], v[60:61] op_sel:[1,1,0] op_sel_hi:[0,1,1] neg_hi:[0,1,0]
    v_pk_mul_f32 v[90:91], v[80:81], v[88:89] op_sel_hi:[1,0]
    v_pk_fma_f32 v[94:95], v[80:81], v[88:89], v[90:91] op_sel:[1,1,0] op_sel_hi:[0,1,1] neg_hi:[0,1,0]
    v_cvt_pk_bf16_f32 v112, v64, v65
    v_cvt_pk_bf16_f32 v113, v94, v95
    ds_write_b64 v2, v[112:113] offset:2112
    ds_write_b64 v2, v[112:113] offset:2640
    v_pk_mul_f32 v[60:61], v[66:67], v[58:59] op_sel_hi:[1,0]
    v_pk_fma_f32 v[62:63], v[66:67], v[58:59], v[60:61] op_sel:[1,1,0] op_sel_hi:[0,1,1] neg_hi:[0,1,0]
    v_pk_mul_f32 v[90:91], v[96:97], v[88:89] op_sel_hi:[1,0]
    v_pk_fma_f32 v[92:93], v[96:97], v[88:89], v[90:91] op_sel:[1,1,0] op_sel_hi:[0,1,1] neg_hi:[0,1,0]
    v_cvt_pk_bf16_f32 v114, v62, v63
    v_cvt_pk_bf16_f32 v115, v92, v93
    ds_write_b64 v2, v[114:115] offset:3168
    v_pk_mul_f32 v[60:61], v[70:71], v[58:59] op_sel_hi:[1,0]
    v_pk_fma_f32 v[62:63], v[70:71], v[58:59], v[60:61] op_sel:[1,1,0] op_sel_hi:[0,1,1] neg_hi:[0,1,0]
    v_pk_mul_f32 v[90:91], v[100:101], v[88:89] op_sel_hi:[1,0]
    v_pk_fma_f32 v[92:93], v[100:101], v[88:89], v[90:91] op_sel:[1,1,0] op_sel_hi:[0,1,1] neg_hi:[0,1,0]
    v_cvt_pk_bf16_f32 v116, v62, v63
    v_cvt_pk_bf16_f32 v117, v92, v93
    ds_write_b64 v2, v[116:117] offset:7392
    v_pk_mul_f32 v[60:61], v[68:69], v[58:59] op_sel_hi:[1,0]
    v_pk_fma_f32 v[62:63], v[68:69], v[58:59], v[60:61] op_sel:[1,1,0] op_sel_hi:[0,1,1] neg_hi:[0,1,0]
    v_pk_mul_f32 v[90:91], v[98:99], v[88:89] op_sel_hi:[1,0]
    v_pk_fma_f32 v[92:93], v[98:99], v[88:89], v[90:91] op_sel:[1,1,0] op_sel_hi:[0,1,1] neg_hi:[0,1,0]
    v_cvt_pk_bf16_f32 v118, v62, v63
    v_cvt_pk_bf16_f32 v119, v92, v93
    ds_write_b64 v2, v[118:119] offset:3696
    ds_write_b64 v2, v[118:119] offset:6336
    ds_write_b64 v2, v[118:119] offset:6864
    v_pk_mul_f32 v[60:61], v[62:63], v[56:57] op_sel_hi:[1,0]
    v_pk_fma_f32 v[62:63], v[62:63], v[56:57], v[60:61] op_sel:[1,1,0] op_sel_hi:[0,1,1] neg_hi:[0,1,0]
    v_pk_mul_f32 v[90:91], v[92:93], v[86:87] op_sel_hi:[1,0]
    v_pk_fma_f32 v[92:93], v[92:93], v[86:87], v[90:91] op_sel:[1,1,0] op_sel_hi:[0,1,1] neg_hi:[0,1,0]
    v_cvt_pk_bf16_f32 v112, v62, v63
    v_cvt_pk_bf16_f32 v113, v92, v93
    ds_write_b64 v2, v[112:113] offset:7920
    v_pk_mul_f32 v[60:61], v[64:65], v[58:59] op_sel_hi:[1,0]
    v_pk_fma_f32 v[64:65], v[64:65], v[58:59], v[60:61] op_sel:[1,1,0] op_sel_hi:[0,1,1] neg_hi:[0,1,0]
    v_pk_mul_f32 v[90:91], v[94:95], v[88:89] op_sel_hi:[1,0]
    v_pk_fma_f32 v[94:95], v[94:95], v[88:89], v[90:91] op_sel:[1,1,0] op_sel_hi:[0,1,1] neg_hi:[0,1,0]
    v_cvt_pk_bf16_f32 v114, v64, v65
    v_cvt_pk_bf16_f32 v115, v94, v95
    ds_write_b64 v2, v[114:115] offset:8448
    v_pk_mul_f32 v[60:61], v[64:65], v[56:57] op_sel_hi:[1,0]
    v_pk_fma_f32 v[62:63], v[64:65], v[56:57], v[60:61] op_sel:[1,1,0] op_sel_hi:[0,1,1] neg_hi:[0,1,0]
    v_pk_mul_f32 v[90:91], v[94:95], v[86:87] op_sel_hi:[1,0]
    v_pk_fma_f32 v[92:93], v[94:95], v[86:87], v[90:91] op_sel:[1,1,0] op_sel_hi:[0,1,1] neg_hi:[0,1,0]
    v_cvt_pk_bf16_f32 v116, v62, v63
    v_cvt_pk_bf16_f32 v117, v92, v93
    ds_write_b64 v2, v[116:117] offset:8976
    v_pk_mul_f32 v[60:61], v[64:65], v[58:59] op_sel_hi:[1,0]
    v_pk_fma_f32 v[64:65], v[64:65], v[58:59], v[60:61] op_sel:[1,1,0] op_sel_hi:[0,1,1] neg_hi:[0,1,0]
    v_pk_mul_f32 v[90:91], v[94:95], v[88:89] op_sel_hi:[1,0]
    v_pk_fma_f32 v[94:95], v[94:95], v[88:89], v[90:91] op_sel:[1,1,0] op_sel_hi:[0,1,1] neg_hi:[0,1,0]
    v_cvt_pk_bf16_f32 v118, v64, v65
    v_cvt_pk_bf16_f32 v119, v94, v95
    ds_write_b64 v2, v[118:119] offset:10560
    v_pk_mul_f32 v[60:61], v[64:65], v[56:57] op_sel_hi:[1,0]
    v_pk_fma_f32 v[62:63], v[64:65], v[56:57], v[60:61] op_sel:[1,1,0] op_sel_hi:[0,1,1] neg_hi:[0,1,0]
    v_pk_mul_f32 v[90:91], v[94:95], v[86:87] op_sel_hi:[1,0]
    v_pk_fma_f32 v[92:93], v[94:95], v[86:87], v[90:91] op_sel:[1,1,0] op_sel_hi:[0,1,1] neg_hi:[0,1,0]
    v_cvt_pk_bf16_f32 v112, v62, v63
    v_cvt_pk_bf16_f32 v113, v92, v93
    ds_write_b64 v2, v[112:113] offset:11088
    v_pk_mul_f32 v[60:61], v[64:65], v[58:59] op_sel_hi:[1,0]
    v_pk_fma_f32 v[64:65], v[64:65], v[58:59], v[60:61] op_sel:[1,1,0] op_sel_hi:[0,1,1] neg_hi:[0,1,0]
    v_pk_mul_f32 v[90:91], v[94:95], v[88:89] op_sel_hi:[1,0]
    v_pk_fma_f32 v[94:95], v[94:95], v[88:89], v[90:91] op_sel:[1,1,0] op_sel_hi:[0,1,1] neg_hi:[0,1,0]
    v_cvt_pk_bf16_f32 v114, v64, v65
    v_cvt_pk_bf16_f32 v115, v94, v95
    ds_write_b64 v2, v[114:115] offset:9504
    v_pk_mul_f32 v[60:61], v[64:65], v[58:59] op_sel_hi:[1,0]
    v_pk_fma_f32 v[64:65], v[64:65], v[58:59], v[60:61] op_sel:[1,1,0] op_sel_hi:[0,1,1] neg_hi:[0,1,0]
    v_pk_mul_f32 v[90:91], v[94:95], v[88:89] op_sel_hi:[1,0]
    v_pk_fma_f32 v[94:95], v[94:95], v[88:89], v[90:91] op_sel:[1,1,0] op_sel_hi:[0,1,1] neg_hi:[0,1,0]
    v_cvt_pk_bf16_f32 v116, v64, v65
    v_cvt_pk_bf16_f32 v117, v94, v95
    ds_write_b64 v2, v[116:117] offset:11616
    v_pk_mul_f32 v[60:61], v[64:65], v[58:59] op_sel_hi:[1,0]
    v_pk_fma_f32 v[64:65], v[64:65], v[58:59], v[60:61] op_sel:[1,1,0] op_sel_hi:[0,1,1] neg_hi:[0,1,0]
    v_pk_mul_f32 v[90:91], v[94:95], v[88:89] op_sel_hi:[1,0]
    v_pk_fma_f32 v[94:95], v[94:95], v[88:89], v[90:91] op_sel:[1,1,0] op_sel_hi:[0,1,1] neg_hi:[0,1,0]
    v_cvt_pk_bf16_f32 v118, v64, v65
    v_cvt_pk_bf16_f32 v119, v94, v95
    ds_write_b64 v2, v[118:119] offset:10032
    v_pk_mul_f32 v[60:61], v[64:65], v[58:59] op_sel_hi:[1,0]
    v_pk_fma_f32 v[64:65], v[64:65], v[58:59], v[60:61] op_sel:[1,1,0] op_sel_hi:[0,1,1] neg_hi:[0,1,0]
    v_pk_mul_f32 v[90:91], v[94:95], v[88:89] op_sel_hi:[1,0]
    v_pk_fma_f32 v[94:95], v[94:95], v[88:89], v[90:91] op_sel:[1,1,0] op_sel_hi:[0,1,1] neg_hi:[0,1,0]
    v_cvt_pk_bf16_f32 v112, v64, v65
    v_cvt_pk_bf16_f32 v113, v94, v95
L_pg2:
    s_cbranch_execz L_back
    ds_write_b64 v2, v[112:113] offset:12144
    v_pk_mul_f32 v[60:61], v[64:65], v[58:59] op_sel_hi:[1,0]
    v_pk_fma_f32 v[64:65], v[64:65], v[58:59], v[60:61] op_sel:[1,1,0] op_sel_hi:[0,1,1] neg_hi:[0,1,0]
    v_pk_mul_f32 v[90:91], v[94:95], v[88:89] op_sel_hi:[1,0]
    v_pk_fma_f32 v[94:95], v[94:95], v[88:89], v[90:91] op_sel:[1,1,0] op_sel_hi:[0,1,1] neg_hi:[0,1,0]
    v_cvt_pk_bf16_f32 v114, v64, v65
    v_cvt_pk_bf16_f32 v115, v94, v95
    ds_write_b64 v2, v[114:115] offset:12672
    s_waitcnt lgkmcnt(0)
    s_barrier
    s_waitcnt vmcnt(2)
    v_perm_b32 v13, v18, v16, s46
    v_perm_b32 v14, v18, v16, s47
    v_perm_b32 v15, v19, v17, s46
    v_perm_b32 v120, v19, v17, s47
    ds_write_b32 v8, v13 offset:0
    ds_write_b32 v8, v14 offset:5120
    ds_write_b32 v8, v15 offset:10240
    ds_write_b32 v8, v120 offset:15360
    v_perm_b32 v13, v22, v20, s46
    v_perm_b32 v14, v22, v20, s47
    v_perm_b32 v15, v23, v21, s46
    v_perm_b32 v120, v23, v21, s47
    ds_write_b32 v8, v13 offset:256
    ds_write_b32 v8, v14 offset:5376
    ds_write_b32 v8, v15 offset:10496
    ds_write_b32 v8, v120 offset:15616
    global_load_dwordx2 v[16:17], v9, s[56:57]
    global_load_dwordx2 v[18:19], v9, s[56:57] offset:1024
    v_mov_b32 v32, 0
    v_mov_b32 v33, 0
    v_mov_b32 v34, 0
    v_mov_b32 v35, 0
    ds_write_b128 v10, v[32:35]
    v_lshl_add_u32 v13, v24, 1, v10
    v_cmp_gt_u32 vcc, 8, v24
    s_and_saveexec_b64 s[40:41], vcc
    ds_write_b16 v13, v121
    s_mov_b64 exec, s[40:41]
    ds_read_b128 v[24:27], v10
    s_waitcnt lgkmcnt(0)
    s_barrier
    ds_read_b128 a[92:95], v7 offset:240
    ds_read_b64 a[0:1], v6 offset:4032
    ds_read_b64 a[2:3], v6 offset:4040
    ds_read_b128 a[124:127], v7 offset:496
    ds_read_b128 a[88:91], v7 offset:208
    ds_read_b64 a[4:5], v6 offset:3904
    ds_read_b64 a[6:7], v6 offset:3912
    ds_read_b128 a[120:123], v7 offset:464
    ds_read_b128 a[84:87], v7 offset:176
    ds_read_b64 a[8:9], v6 offset:3776
    s_waitcnt lgkmcnt(7)
    v_mfma_f32_16x16x32_bf16 v[32:35], a[0:3], a[92:95], 0
    ds_read_b64 a[10:11], v6 offset:3784
    s_waitcnt lgkmcnt(7)
    v_mfma_f32_16x16x32_bf16 v[36:39], a[0:3], a[124:127], 0
    ds_read_b128 a[116:119], v7 offset:432
    v_mfma_f32_16x16x32_bf16 v[32:35], v[24:27], a[92:95], v[32:35]
    ds_read_b128 a[80:83], v7 offset:144
    ds_read_b64 a[12:13], v6 offset:3648
    ds_read_b64 a[14:15], v6 offset:3656
    s_waitcnt lgkmcnt(8)
    v_mfma_f32_16x16x32_bf16 v[32:35], a[4:7], a[88:91], v[32:35]
    ds_read_b128 a[112:115], v7 offset:400
    s_waitcnt lgkmcnt(8)
    v_mfma_f32_16x16x32_bf16 v[36:39], a[4:7], a[120:123], v[36:39]
    ds_read_b128 a[76:79], v7 offset:112
    ds_read_b64 a[16:17], v6 offset:3520
    ds_read_b64 a[18:19], v6 offset:3528
    s_waitcnt lgkmcnt(8)
    v_mfma_f32_16x16x32_bf16 v[32:35], a[8:11], a[84:87], v[32:35]
    ds_read_b128 a[108:111], v7 offset:368
    s_waitcnt lgkmcnt(8)
    v_mfma_f32_16x16x32_bf16 v[36:39], a[8:11], a[116:119], v[36:39]
    ds_read_b128 a[72:75], v7 offset:80
    ds_read_b64 a[20:21], v6 offset:3392
    ds_read_b64 a[22:23], v6 offset:3400
    s_waitcnt lgkmcnt(8)
    v_mfma_f32_16x16x32_bf16 v[32:35], a[12:15], a[80:83], v[32:35]
    ds_read_b128 a[104:107], v7 offset:336
    s_waitcnt lgkmcnt(8)
    v_mfma_f32_16x16x32_bf16 v[36:39], a[12:15], a[112:115], v[36:39]
    ds_read_b128 a[68:71], v7 offset:48
    ds_read_b64 a[24:25], v6 offset:3264
    ds_read_b64 a[26:27], v6 offset:3272
    s_waitcnt lgkmcnt(8)
    v_mfma_f32_16x16x32_bf16 v[32:35], a[16:19], a[76:79], v[32:35]
    ds_read_b128 a[100:103], v7 offset:304
    s_waitcnt lgkmcnt(8)
    v_mfma_f32_16x16x32_bf16 v[36:39], a[16:19], a[108:111], v[36:39]
    ds_read_b128 a[64:67], v7 offset:16
    ds_read_b64 a[28:29], v6 offset:3136
    ds_read_b64 a[30:31], v6 offset:3144
    s_waitcnt lgkmcnt(8)
    v_mfma_f32_16x16x32_bf16 v[32:35], a[20:23], a[72:75], v[32:35]
    ds_read_b128 a[96:99], v7 offset:272
    s_waitcnt lgkmcnt(8)
    v_mfma_f32_16x16x32_bf16 v[36:39], a[20:23], a[104:107], v[36:39]
    s_barrier
    ds_read_b64 a[32:33], v6 offset:3008
    ds_read_b64 a[34:35], v6 offset:3016
    s_waitcnt lgkmcnt(7)
    v_mfma_f32_16x16x32_bf16 v[32:35], a[24:27], a[68:71], v[32:35]
    ds_read_b64 a[36:37], v6 offset:2880
    s_waitcnt lgkmcnt(7)
    v_mfma_f32_16x16x32_bf16 v[36:39], a[24:27], a[100:103], v[36:39]
    s_waitcnt vmcnt(2)
    v_perm_b32 v13, v126, v124, s46
    v_perm_b32 v14, v126, v124, s47
    v_perm_b32 v15, v127, v125, s46
    v_perm_b32 v120, v127, v125, s47
    ds_write_b32 v8, v13 offset:512
    ds_write_b32 v8, v14 offset:5632
    ds_write_b32 v8, v15 offset:10752
    ds_write_b32 v8, v120 offset:15872
    ds_read_b64 a[38:39], v6 offset:2888
    s_waitcnt lgkmcnt(9)
    v_mfma_f32_16x16x32_bf16 v[32:35], a[28:31], a[64:67], v[32:35]
    ds_read_b64 a[40:41], v6 offset:2752
    s_waitcnt lgkmcnt(9)
    v_mfma_f32_16x16x32_bf16 v[36:39], a[28:31], a[96:99], v[36:39]
    ds_read_b64 a[42:43], v6 offset:2760
    s_waitcnt lgkmcnt(8)
    v_mfma_f32_16x16x32_bf16 v[36:39], a[32:35], a[92:95], v[36:39]
    ds_read_b64 a[44:45], v6 offset:2624
    v_mfma_f32_16x16x32_bf16 v[40:43], a[32:35], a[124:127], 0
    ds_write_b128 v10, v[32:35] offset:0
    v_mfma_f32_16x16x32_bf16 v[36:39], v[24:27], a[124:127], v[36:39]
    ds_read_b64 a[46:47], v6 offset:2632
    s_waitcnt lgkmcnt(5)
    v_mfma_f32_16x16x32_bf16 v[36:39], a[36:39], a[88:91], v[36:39]
    ds_read_b64 a[48:49], v6 offset:2496
    v_mfma_f32_16x16x32_bf16 v[40:43], a[36:39], a[120:123], v[40:43]
    ds_read_b64 a[50:51], v6 offset:2504
    s_waitcnt lgkmcnt(5)
    v_mfma_f32_16x16x32_bf16 v[36:39], a[40:43], a[84:87], v[36:39]
    s_waitcnt lgkmcnt(3)
    s_barrier
    s_waitcnt vmcnt(0)
    v_perm_b32 v13, v18, v16, s46
    v_perm_b32 v14, v18, v16, s47
    v_perm_b32 v15, v19, v17, s46
    v_perm_b32 v120, v19, v17, s47
    ds_write_b32 v8, v13 offset:768
    ds_write_b32 v8, v14 offset:5888
    ds_write_b32 v8, v15 offset:11008
    ds_write_b32 v8, v120 offset:16128
    ds_read_b64 a[52:53], v6 offset:2368
    v_mfma_f32_16x16x32_bf16 v[40:43], a[40:43], a[116:119], v[40:43]
    ds_read_b64 a[54:55], v6 offset:2376
    s_waitcnt lgkmcnt(8)
    v_mfma_f32_16x16x32_bf16 v[36:39], a[44:47], a[80:83], v[36:39]
    ds_read_b64 a[56:57], v6 offset:2240
    v_mfma_f32_16x16x32_bf16 v[40:43], a[44:47], a[112:115], v[40:43]
    ds_read_b64 a[58:59], v6 offset:2248
    s_waitcnt lgkmcnt(8)
    v_mfma_f32_16x16x32_bf16 v[36:39], a[48:51], a[76:79], v[36:39]
    ds_read_b64 a[60:61], v6 offset:2112
    v_mfma_f32_16x16x32_bf16 v[40:43], a[48:51], a[108:111], v[40:43]
    ds_read_b64 a[62:63], v6 offset:2120
    s_waitcnt lgkmcnt(4)
    v_mfma_f32_16x16x32_bf16 v[36:39], a[52:55], a[72:75], v[36:39]
    ds_read_b64 v[88:89], v6 offset:1984
    v_mfma_f32_16x16x32_bf16 v[40:43], a[52:55], a[104:107], v[40:43]
    ds_read_b64 v[90:91], v6 offset:1992
    s_waitcnt lgkmcnt(4)
    v_mfma_f32_16x16x32_bf16 v[36:39], a[56:59], a[68:71], v[36:39]
    ds_read_b64 v[92:93], v6 offset:1856
    v_mfma_f32_16x16x32_bf16 v[40:43], a[56:59], a[100:103], v[40:43]
    ds_read_b64 v[94:95], v6 offset:1864
    s_waitcnt lgkmcnt(4)
    v_mfma_f32_16x16x32_bf16 v[36:39], a[60:63], a[64:67], v[36:39]
    ds_read_b64 v[96:97], v6 offset:1728
    v_mfma_f32_16x16x32_bf16 v[40:43], a[60:63], a[96:99], v[40:43]
    ds_read_b64 v[98:99], v6 offset:1736
    s_waitcnt lgkmcnt(4)
    v_mfma_f32_16x16x32_bf16 v[40:43], v[88:91], a[92:95], v[40:43]
    ds_read_b64 v[100:101], v6 offset:1600
    v_mfma_f32_16x16x32_bf16 v[44:47], v[88:91], a[124:127], 0
    s_nop 0
    ds_write_b128 v10, v[36:39] offset:8192
    ds_read_b64 v[102:103], v6 offset:1608
    s_waitcnt lgkmcnt(5)
    v_mfma_f32_16x16x32_bf16 v[40:43], v[92:95], a[88:91], v[40:43]
    ds_read_b64 v[88:89], v6 offset:1472
    v_mfma_f32_16x16x32_bf16 v[44:47], v[92:95], a[120:123], v[44:47]
    ds_read_b64 v[90:91], v6 offset:1480
    s_waitcnt lgkmcnt(5)
    v_mfma_f32_16x16x32_bf16 v[40:43], v[96:99], a[84:87], v[40:43]
    ds_read_b64 v[92:93], v6 offset:1344
    v_mfma_f32_16x16x32_bf16 v[44:47], v[96:99], a[116:119], v[44:47]
    s_waitcnt lgkmcnt(4)
    s_barrier
    ds_read2st64_b32 v[104:105], v11 offset0:32 offset1:36
    ds_read2st64_b32 v[106:107], v11 offset0:40 offset1:44
    ds_read2st64_b32 v[108:109], v11 offset0:48 offset1:52
    ds_read2st64_b32 v[110:111], v11 offset0:56 offset1:60
    s_waitcnt lgkmcnt(0)
    v_add_f32 v104, v104, v105
    v_add_f32 v106, v106, v107
    v_add_f32 v108, v108, v109
    v_add_f32 v110, v110, v111
    v_cvt_pk_bf16_f32 v104, v104, v106
    v_cvt_pk_bf16_f32 v105, v108, v110
    global_store_dwordx2 v12, v[104:105], s[58:59]
    ds_read_b64 v[94:95], v6 offset:1352
    v_mfma_f32_16x16x32_bf16 v[40:43], v[100:103], a[80:83], v[40:43]
    ds_read_b64 v[96:97], v6 offset:1216
    v_mfma_f32_16x16x32_bf16 v[44:47], v[100:103], a[112:115], v[44:47]
    ds_read_b64 v[98:99], v6 offset:1224
    v_mfma_f32_16x16x32_bf16 v[40:43], v[88:91], a[76:79], v[40:43]
    ds_read_b64 v[100:101], v6 offset:1088
    v_mfma_f32_16x16x32_bf16 v[44:47], v[88:91], a[108:111], v[44:47]
    ds_read_b64 v[102:103], v6 offset:1096
    s_waitcnt lgkmcnt(4)
    v_mfma_f32_16x16x32_bf16 v[40:43], v[92:95], a[72:75], v[40:43]
    ds_read_b128 v[48:51], v7 offset:528
    v_mfma_f32_16x16x32_bf16 v[44:47], v[92:95], a[104:107], v[44:47]
    ds_read_b128 v[52:55], v7 offset:560
    s_waitcnt lgkmcnt(4)
    v_mfma_f32_16x16x32_bf16 v[40:43], v[96:99], a[68:71], v[40:43]
    ds_read_b128 v[56:59], v7 offset:592
    v_mfma_f32_16x16x32_bf16 v[44:47], v[96:99], a[100:103], v[44:47]
    ds_read_b128 v[60:63], v7 offset:624
    s_waitcnt lgkmcnt(4)
    v_mfma_f32_16x16x32_bf16 v[40:43], v[100:103], a[64:67], v[40:43]
    v_mfma_f32_16x16x32_bf16 v[44:47], v[100:103], a[96:99], v[44:47]
    s_waitcnt lgkmcnt(3)
    v_mfma_f32_16x16x32_bf16 v[40:43], a[28:31], v[48:51], v[40:43]
    v_mfma_f32_16x16x32_bf16 v[44:47], a[60:63], v[48:51], v[44:47]
    ds_read_b128 v[48:51], v7 offset:656
    s_waitcnt lgkmcnt(3)
    v_mfma_f32_16x16x32_bf16 v[40:43], a[24:27], v[52:55], v[40:43]
    v_mfma_f32_16x16x32_bf16 v[44:47], a[56:59], v[52:55], v[44:47]
    ds_read_b128 v[52:55], v7 offset:688
    s_waitcnt lgkmcnt(3)
    v_mfma_f32_16x16x32_bf16 v[40:43], a[20:23], v[56:59], v[40:43]
    v_mfma_f32_16x16x32_bf16 v[44:47], a[52:55], v[56:59], v[44:47]
    ds_read_b128 v[56:59], v7 offset:720
    s_waitcnt lgkmcnt(3)
    v_mfma_f32_16x16x32_bf16 v[40:43], a[16:19], v[60:63], v[40:43]
    v_mfma_f32_16x16x32_bf16 v[44:47], a[48:51], v[60:63], v[44:47]
    ds_read_b128 v[60:63], v7 offset:752
    s_waitcnt lgkmcnt(3)
    v_mfma_f32_16x16x32_bf16 v[40:43], a[12:15], v[48:51], v[40:43]
    ds_read_b64 v[88:89], v6 offset:960
    v_mfma_f32_16x16x32_bf16 v[44:47], a[44:47], v[48:51], v[44:47]
    ds_read_b64 v[90:91], v6 offset:968
    s_waitcnt lgkmcnt(4)
    v_mfma_f32_16x16x32_bf16 v[40:43], a[8:11], v[52:55], v[40:43]
    ds_read_b128 v[48:51], v7 offset:784
    v_mfma_f32_16x16x32_bf16 v[44:47], a[40:43], v[52:55], v[44:47]
    ds_read_b64 v[92:93], v6 offset:832
    s_waitcnt lgkmcnt(5)
    v_mfma_f32_16x16x32_bf16 v[40:43], a[4:7], v[56:59], v[40:43]
    ds_read_b64 v[94:95], v6 offset:840
    v_mfma_f32_16x16x32_bf16 v[44:47], a[36:39], v[56:59], v[44:47]
    ds_read_b128 v[52:55], v7 offset:816
    s_waitcnt lgkmcnt(6)
    v_mfma_f32_16x16x32_bf16 v[40:43], a[0:3], v[60:63], v[40:43]
    ds_read_b64 v[96:97], v6 offset:704
    v_mfma_f32_16x16x32_bf16 v[44:47], a[32:35], v[60:63], v[44:47]
    ds_read_b64 v[98:99], v6 offset:712
    v_mfma_f32_16x16x32_bf16 v[40:43], v[24:27], v[60:63], v[40:43]
    ds_read_b128 v[56:59], v7 offset:848
    s_waitcnt lgkmcnt(7)
    v_mfma_f32_16x16x32_bf16 v[44:47], v[88:91], a[92:95], v[44:47]
    ds_read_b64 v[100:101], v6 offset:576
    s_waitcnt lgkmcnt(7)
    v_mfma_f32_16x16x32_bf16 v[44:47], a[28:31], v[48:51], v[44:47]
    ds_read_b64 v[102:103], v6 offset:584
    s_waitcnt lgkmcnt(6)
    v_mfma_f32_16x16x32_bf16 v[44:47], v[92:95], a[88:91], v[44:47]
    ds_write_b128 v10, v[40:43] offset:0
    ds_read_b128 v[60:63], v7 offset:880
    s_waitcnt lgkmcnt(7)
    v_mfma_f32_16x16x32_bf16 v[44:47], a[24:27], v[52:55], v[44:47]
    ds_read_b64 v[88:89], v6 offset:448
    ds_read_b64 v[90:91], v6 offset:456
    s_waitcnt lgkmcnt(7)
    v_mfma_f32_16x16x32_bf16 v[44:47], v[96:99], a[84:87], v[44:47]
    ds_read_b128 v[48:51], v7 offset:912
    s_waitcnt lgkmcnt(7)
    v_mfma_f32_16x16x32_bf16 v[44:47], a[20:23], v[56:59], v[44:47]
    ds_read_b64 v[92:93], v6 offset:320
    ds_read_b64 v[94:95], v6 offset:328
    s_waitcnt lgkmcnt(7)
    v_mfma_f32_16x16x32_bf16 v[44:47], v[100:103], a[80:83], v[44:47]
    s_waitcnt lgkmcnt(6)
    s_barrier
    ds_read_b128 v[52:55], v7 offset:944
    s_waitcnt lgkmcnt(6)
    v_mfma_f32_16x16x32_bf16 v[44:47], a[16:19], v[60:63], v[44:47]
    ds_read_b64 v[96:97], v6 offset:192
    ds_read_b64 v[98:99], v6 offset:200
    s_waitcnt lgkmcnt(6)
    v_mfma_f32_16x16x32_bf16 v[44:47], v[88:91], a[76:79], v[44:47]
    ds_read_b128 v[56:59], v7 offset:976
    s_waitcnt lgkmcnt(6)
    v_mfma_f32_16x16x32_bf16 v[44:47], a[12:15], v[48:51], v[44:47]
    ds_read_b64 v[100:101], v6 offset:64
    ds_read_b64 v[102:103], v6 offset:72
    s_waitcnt lgkmcnt(6)
    v_mfma_f32_16x16x32_bf16 v[44:47], v[92:95], a[72:75], v[44:47]
    ds_read_b128 v[60:63], v7 offset:1008
    s_waitcnt lgkmcnt(6)
    v_mfma_f32_16x16x32_bf16 v[44:47], a[8:11], v[52:55], v[44:47]
    s_waitcnt lgkmcnt(4)
    v_mfma_f32_16x16x32_bf16 v[44:47], v[96:99], a[68:71], v[44:47]
    s_waitcnt lgkmcnt(3)
    v_mfma_f32_16x16x32_bf16 v[44:47], a[4:7], v[56:59], v[44:47]
    s_waitcnt lgkmcnt(1)
    v_mfma_f32_16x16x32_bf16 v[44:47], v[100:103], a[64:67], v[44:47]
    s_waitcnt lgkmcnt(0)
    v_mfma_f32_16x16x32_bf16 v[44:47], a[0:3], v[60:63], v[44:47]
    v_mfma_f32_16x16x32_bf16 v[44:47], v[24:27], v[60:63], v[44:47]
    s_nop 7
    ds_write_b128 v10, v[44:47] offset:8192
    s_waitcnt lgkmcnt(0)
    s_barrier
    ds_read2st64_b32 v[104:105], v11 offset0:32 offset1:36
    ds_read2st64_b32 v[106:107], v11 offset0:40 offset1:44
    ds_read2st64_b32 v[108:109], v11 offset0:48 offset1:52
    ds_read2st64_b32 v[110:111], v11 offset0:56 offset1:60
    s_waitcnt lgkmcnt(0)
    v_add_f32 v104, v104, v105
    v_add_f32 v106, v106, v107
    v_add_f32 v108, v108, v109
    v_add_f32 v110, v110, v111
    v_cvt_pk_bf16_f32 v104, v104, v106
    v_cvt_pk_bf16_f32 v105, v108, v110
    global_store_dwordx2 v12, v[104:105], s[60:61]
L_fin:
L_end:
    s_endpgm
.section .rodata,"a"
.p2align 6
.amdhsa_kernel standalone__ssm_conv_s4__prompt_kernel
  .amdhsa_next_free_vgpr 256
  .amdhsa_next_free_sgpr 72
  .amdhsa_accum_offset 128
  .amdhsa_group_segment_fixed_size 0
  .amdhsa_kernarg_size 96
  .amdhsa_user_sgpr_count 2
  .amdhsa_user_sgpr_kernarg_segment_ptr 1
  .amdhsa_system_sgpr_workgroup_id_x 1
.end_amdhsa_kernel
```
